```python
import torch

def _softmax(x, axis=-1):
    return torch.softmax(x, dim=axis)
def _gelu(x):
    return torch.nn.functional.gelu(x, approximate="tanh")
def _silu(x):
    return torch.nn.functional.silu(x)
def _sigmoid(x):
    return torch.sigmoid(x)
def _layernorm(x, axis=-1, eps=1e-5):
    m = x.mean(dim=axis, keepdim=True)
    v = x.var(dim=axis, keepdim=True, unbiased=False)
    return (x - m) / torch.sqrt(v + eps)
def _scatter_add(tgt, idx, src, axis=0):
    return tgt.clone().index_add_(axis, idx, src)
def _segment_sum(src, seg, n):
    out = torch.zeros((n,) + src.shape[1:], dtype=src.dtype)
    return out.index_add_(0, seg, src)
def _pad(x, pw):
    flat = tuple(v for pair in reversed(pw) for v in pair)
    return torch.nn.functional.pad(x, flat)

kernel_name = 'recurrent_scan__mha_block_cached__mixer_token_mlp__decode'

def setup_inputs():

    _w = (lambda a: (lambda t: t.to(torch.bfloat16) if t.is_floating_point() else t)(torch.as_tensor(a)))
    def _A_setup():
        B, Sq, D = 8, 1, 512
        H, Sk, Dh = 32, 8192, 128
        return {
            "x": _w((lambda *s: torch.randn(*s, dtype=torch.bfloat16) * 0.4)(B, Sq, D)),
            "k_cache": _w((lambda *s: torch.randn(*s, dtype=torch.bfloat16) * 1.6)(B, H, Sk, Dh)),
            "v_cache": _w((lambda *s: torch.randn(*s, dtype=torch.bfloat16) * 1.6)(B, H, Sk, Dh)),
            "wq": _w((lambda *s: torch.randn(*s, dtype=torch.bfloat16) * 1.6)(D, H * Dh) * (D ** -0.5)),
            "wo": _w((lambda *s: torch.randn(*s, dtype=torch.bfloat16) * 1.6)(H * Dh, D) * ((H * Dh) ** -0.5)),
        }
    _A_in = _A_setup()

    def _B_setup():
        B, S, D, F = 8, 1, 512, 1792
        return {
            "x": _w((lambda *s: torch.randn(*s, dtype=torch.bfloat16) * 0.4)(B, S, D)),
            "w1": _w((lambda *s: torch.randn(*s, dtype=torch.bfloat16) * 1.6)(S, F) * (S ** -0.5)),
            "b1": _w((lambda *s: torch.randn(*s, dtype=torch.bfloat16) * 1.6)(F) * 0.02),
            "w2": _w((lambda *s: torch.randn(*s, dtype=torch.bfloat16) * 1.6)(F, S) * (F ** -0.5)),
            "b2": _w((lambda *s: torch.randn(*s, dtype=torch.bfloat16) * 1.6)(S) * 0.02),
        }
    _B_in = _B_setup()

    return {
        "A_x": _A_in["x"],
        "A_k_cache": _A_in["k_cache"],
        "A_v_cache": _A_in["v_cache"],
        "A_wq": _A_in["wq"],
        "A_wo": _A_in["wo"],
        "B_x": _B_in["x"],
        "B_w1": _B_in["w1"],
        "B_b1": _B_in["b1"],
        "B_w2": _B_in["w2"],
        "B_b2": _B_in["b2"],
    }

def reference(A_x, A_k_cache, A_v_cache, A_wq, A_wo, B_x, B_w1, B_b1, B_w2, B_b2):
    def _A_ref(x, k_cache, v_cache, wq, wo):
        B, Sq, D = x.shape
        H, Dh = 32, 128
        q = (lambda x, *d: x.permute(*d))((x @ wq).reshape(B, Sq, H, Dh), 0, 2, 1, 3)
        scores = torch.einsum("bhqd,bhkd->bhqk", q, k_cache) * (Dh ** -0.5)
        p = _softmax(scores, axis=-1)
        o = torch.einsum("bhqk,bhkd->bhqd", p, v_cache)
        return (lambda x, *d: x.permute(*d))(o, 0, 2, 1, 3).reshape(B, Sq, H * Dh) @ wo

    def _B_ref(x, w1, b1, w2, b2):
        B, S, D = x.shape
        h = _layernorm(x, axis=-1)
        u = torch.einsum("bsd,sf->bdf", h, w1) + b1
        u = _gelu(u)
        y = torch.einsum("bdf,fs->bds", u, w2) + b2
        return (lambda x, *d: x.permute(*d))(y, 0, 2, 1)

    x = A_x
    xn = _layernorm(x, axis=-1)
    s = _A_ref(xn, A_k_cache, A_v_cache, A_wq, A_wo)
    g = _silu(_B_ref(xn, B_w1, B_b1, B_w2, B_b2))
    return x + s * g
```

```asm
; @launch grid=(256,1,1) block=(512,1,1) lds=139776
.amdgcn_target "amdgcn-amd-amdhsa--gfx950"
.text
.globl recurrent_scan__mha_block_cached__mixer_token_mlp__decode_kernel
.p2align 8
.type recurrent_scan__mha_block_cached__mixer_token_mlp__decode_kernel,@function
recurrent_scan__mha_block_cached__mixer_token_mlp__decode_kernel:
    s_cmp_ge_u32 s2, 256
    s_cbranch_scc1 L_end
    s_load_dwordx16 s[16:31], s[0:1], 0
    s_load_dwordx8 s[32:39], s[0:1], 64
    s_load_dwordx2 s[40:41], s[0:1], 96
    v_lshrrev_b32 v2, 6, v0
    v_and_b32 v1, 63, v0
    v_readfirstlane_b32 s3, v2
    s_lshr_b32 s42, s2, 5
    s_and_b32 s43, s2, 31
    v_and_b32 v8, 1, v1
    v_lshlrev_b32 v8, 4, v8
    v_mov_b32 v9, 0xffff
    v_lshlrev_b32 v8, v8, v9
    v_bfe_u32 v9, v1, 1, 3
    v_cmp_eq_u32 vcc, 0, v9
    s_nop 1
    v_cndmask_b32 v4, 0, v8, vcc
    v_cmp_eq_u32 vcc, 1, v9
    s_nop 1
    v_cndmask_b32 v5, 0, v8, vcc
    v_cmp_eq_u32 vcc, 2, v9
    s_nop 1
    v_cndmask_b32 v6, 0, v8, vcc
    v_cmp_eq_u32 vcc, 3, v9
    s_nop 1
    v_cndmask_b32 v7, 0, v8, vcc
    s_cmp_ge_u32 s3, 4
    s_cbranch_scc1 L_helper
    v_and_b32 v2, 3, v1
    v_lshlrev_b32 v2, 4, v2
    v_bfe_u32 v10, v1, 2, 2
    v_lshl_add_u32 v2, v10, 8, v2
    v_lshrrev_b32 v10, 4, v1
    v_lshl_add_u32 v2, v10, 6, v2
    v_lshlrev_b32 v3, 4, v1
    s_lshl_b32 s55, s2, 21
    s_mul_i32 s52, s3, 4096
    s_mov_b32 s53, s52
    s_mov_b32 s46, 0x200000
    s_mov_b32 s47, 0x20000
    s_waitcnt lgkmcnt(0)
    s_add_u32 s44, s18, s55
    s_addc_u32 s45, s19, 0
    s_add_u32 s48, s20, s55
    s_addc_u32 s49, s21, 0
    s_mov_b32 s50, 0x200000
    s_mov_b32 s51, 0x20000
    s_mul_i32 s56, s3, 24576
    s_add_u32 s56, s56, 41472
    s_setprio 3
    buffer_load_dwordx4 v[64:67], v2, s[44:47], s52 offen offset:0 nt
    buffer_load_dwordx4 v[68:71], v2, s[44:47], s52 offen offset:1024 nt
    buffer_load_dwordx4 v[72:75], v2, s[44:47], s52 offen offset:2048 nt
    buffer_load_dwordx4 v[76:79], v2, s[44:47], s52 offen offset:3072 nt
    s_add_u32 s52, s52, 16384
    buffer_load_dwordx4 v[80:83], v2, s[44:47], s52 offen offset:0 nt
    buffer_load_dwordx4 v[84:87], v2, s[44:47], s52 offen offset:1024 nt
    v_mov_b32 v8, 0xff7fffff
    v_mov_b32 v9, 0
    v_mov_b32 v10, 0
    s_lshl_b32 s55, s3, 13
    s_add_u32 s55, s55, 8192
    v_lshl_add_u32 v28, v1, 2, s55
    v_mov_b32 v20, 0
    v_mov_b32 v21, 0
    v_mov_b32 v22, 0
    v_mov_b32 v23, 0
    v_add_u32 v31, s56, v3
    v_lshrrev_b32 v11, 2, v1
    v_lshlrev_b32 v11, 5, v11
    v_and_b32 v12, 3, v1
    s_lshl_b32 s55, s3, 2
    s_add_u32 s55, s55, 2304
    v_mov_b32 v49, s55
    v_add_u32 v50, 16, v49
    v_mov_b32 v48, 12
    v_mov_b32 v51, 1
    s_mov_b32 s57, 1
    ds_write_b32 v49, v48
    ds_write_b32 v50, v51
    ds_write_b32 v10, v10 offset:2336
    s_waitcnt lgkmcnt(0)
    s_waitcnt vmcnt(5)
    buffer_load_dwordx4 v[88:91], v2, s[44:47], s52 offen offset:2048 nt
    s_waitcnt vmcnt(5)
    buffer_load_dwordx4 v[92:95], v2, s[44:47], s52 offen offset:3072 nt
    s_add_u32 s52, s52, 16384
    s_waitcnt vmcnt(5)
    buffer_load_dwordx4 v[96:99], v2, s[44:47], s52 offen offset:0 nt
    s_waitcnt vmcnt(5)
    buffer_load_dwordx4 v[100:103], v2, s[44:47], s52 offen offset:1024 nt
    s_waitcnt vmcnt(5)
    buffer_load_dwordx4 v[104:107], v2, s[44:47], s52 offen offset:2048 nt
    s_waitcnt vmcnt(5)
    buffer_load_dwordx4 v[108:111], v2, s[44:47], s52 offen offset:3072 nt
    s_add_u32 s52, s52, 16384
    s_waitcnt vmcnt(5)
    buffer_load_dwordx4 v[112:115], v2, s[44:47], s52 offen offset:0 nt
    s_waitcnt vmcnt(5)
    buffer_load_dwordx4 v[116:119], v2, s[44:47], s52 offen offset:1024 nt
    s_waitcnt vmcnt(5)
    buffer_load_dwordx4 v[120:123], v2, s[44:47], s52 offen offset:2048 nt
    s_waitcnt vmcnt(5)
    buffer_load_dwordx4 v[124:127], v2, s[44:47], s52 offen offset:3072 nt
    s_add_u32 s52, s52, 16384
    s_waitcnt vmcnt(5)
    buffer_load_dwordx4 v[128:131], v2, s[44:47], s52 offen offset:0 nt
    s_waitcnt vmcnt(5)
    buffer_load_dwordx4 v[132:135], v2, s[44:47], s52 offen offset:1024 nt
    s_waitcnt vmcnt(5)
    buffer_load_dwordx4 v[136:139], v2, s[44:47], s52 offen offset:2048 nt
    s_waitcnt vmcnt(5)
    buffer_load_dwordx4 v[140:143], v2, s[44:47], s52 offen offset:3072 nt
    s_add_u32 s52, s52, 16384
    s_waitcnt vmcnt(5)
    buffer_load_dwordx4 v[144:147], v2, s[44:47], s52 offen offset:0 nt
    s_waitcnt vmcnt(5)
    buffer_load_dwordx4 v[148:151], v2, s[44:47], s52 offen offset:1024 nt
    s_waitcnt vmcnt(5)
    buffer_load_dwordx4 v[152:155], v2, s[44:47], s52 offen offset:2048 nt
    s_waitcnt vmcnt(5)
    buffer_load_dwordx4 v[156:159], v2, s[44:47], s52 offen offset:3072 nt
    s_add_u32 s52, s52, 16384
    s_waitcnt vmcnt(5)
    buffer_load_dwordx4 v[160:163], v2, s[44:47], s52 offen offset:0 nt
    s_waitcnt vmcnt(5)
    buffer_load_dwordx4 v[164:167], v2, s[44:47], s52 offen offset:1024 nt
    s_waitcnt vmcnt(5)
    buffer_load_dwordx4 v[168:171], v2, s[44:47], s52 offen offset:2048 nt
    s_waitcnt vmcnt(5)
    buffer_load_dwordx4 v[172:175], v2, s[44:47], s52 offen offset:3072 nt
    s_add_u32 s52, s52, 16384
    s_waitcnt vmcnt(5)
    buffer_load_dwordx4 v[176:179], v2, s[44:47], s52 offen offset:0 nt
    s_waitcnt vmcnt(5)
    buffer_load_dwordx4 v[180:183], v2, s[44:47], s52 offen offset:1024 nt
    s_waitcnt vmcnt(5)
    buffer_load_dwordx4 v[184:187], v2, s[44:47], s52 offen offset:2048 nt
    s_waitcnt vmcnt(5)
    buffer_load_dwordx4 v[188:191], v2, s[44:47], s52 offen offset:3072 nt
    s_add_u32 s52, s52, 16384
    s_waitcnt vmcnt(5)
    s_add_u32 m0, s56, 0
    s_nop 0
    buffer_load_dwordx4 v2, s[44:47], s52 offen offset:0 nt lds
    s_waitcnt vmcnt(5)
    buffer_load_dwordx4 v2, s[44:47], s52 offen offset:1024 nt lds
    s_waitcnt vmcnt(5)
    buffer_load_dwordx4 v2, s[44:47], s52 offen offset:2048 nt lds
    s_waitcnt vmcnt(5)
    buffer_load_dwordx4 v2, s[44:47], s52 offen offset:3072 nt lds
    s_add_u32 s52, s52, 16384
    s_waitcnt vmcnt(5)
    s_add_u32 m0, s56, 4096
    s_nop 0
    buffer_load_dwordx4 v2, s[44:47], s52 offen offset:0 nt lds
    s_waitcnt vmcnt(5)
    buffer_load_dwordx4 v2, s[44:47], s52 offen offset:1024 nt lds
    s_waitcnt vmcnt(5)
    buffer_load_dwordx4 v2, s[44:47], s52 offen offset:2048 nt lds
    s_waitcnt vmcnt(5)
    buffer_load_dwordx4 v2, s[44:47], s52 offen offset:3072 nt lds
    s_add_u32 s52, s52, 16384
    s_waitcnt vmcnt(5)
    s_add_u32 m0, s56, 8192
    s_nop 0
    buffer_load_dwordx4 v2, s[44:47], s52 offen offset:0 nt lds
    s_waitcnt vmcnt(5)
    buffer_load_dwordx4 v2, s[44:47], s52 offen offset:1024 nt lds
    s_waitcnt vmcnt(5)
    buffer_load_dwordx4 v2, s[44:47], s52 offen offset:2048 nt lds
    s_waitcnt vmcnt(5)
    buffer_load_dwordx4 v2, s[44:47], s52 offen offset:3072 nt lds
    s_add_u32 s52, s52, 16384
    s_waitcnt vmcnt(5)
    s_add_u32 m0, s56, 12288
    s_nop 0
    buffer_load_dwordx4 v2, s[44:47], s52 offen offset:0 nt lds
    s_waitcnt vmcnt(5)
    buffer_load_dwordx4 v2, s[44:47], s52 offen offset:1024 nt lds
    s_waitcnt vmcnt(5)
    buffer_load_dwordx4 v2, s[44:47], s52 offen offset:2048 nt lds
    s_waitcnt vmcnt(5)
    buffer_load_dwordx4 v2, s[44:47], s52 offen offset:3072 nt lds
    s_add_u32 s52, s52, 16384
    s_add_u32 m0, s56, 16384
    s_nop 0
    buffer_load_dwordx4 v2, s[44:47], s52 offen offset:0 nt lds
    s_barrier
    ds_read_b128 v[192:195], v11 offset:0
    ds_read_b128 v[196:199], v11 offset:16
    ds_read_b128 v[200:203], v11 offset:512
    ds_read_b128 v[204:207], v11 offset:528
    ds_read_b128 v[208:211], v11 offset:1024
    ds_read_b128 v[212:215], v11 offset:1040
    ds_read_b128 v[216:219], v11 offset:1536
    ds_read_b128 v[220:223], v11 offset:1552
    s_waitcnt vmcnt(5)
    buffer_load_dwordx4 v2, s[44:47], s52 offen offset:1024 nt lds
    s_waitcnt vmcnt(5)
    buffer_load_dwordx4 v2, s[44:47], s52 offen offset:2048 nt lds
    s_waitcnt lgkmcnt(0)
    v_add_f32 v192, v192, v200
    v_add_f32 v208, v208, v216
    v_add_f32 v193, v193, v201
    v_add_f32 v209, v209, v217
    v_add_f32 v194, v194, v202
    v_add_f32 v210, v210, v218
    v_add_f32 v195, v195, v203
    v_add_f32 v211, v211, v219
    v_add_f32 v196, v196, v204
    v_add_f32 v212, v212, v220
    v_add_f32 v197, v197, v205
    v_add_f32 v213, v213, v221
    v_add_f32 v198, v198, v206
    v_add_f32 v214, v214, v222
    v_add_f32 v199, v199, v207
    v_add_f32 v215, v215, v223
    s_waitcnt vmcnt(5)
    buffer_load_dwordx4 v2, s[44:47], s52 offen offset:3072 nt lds
    s_add_u32 s52, s52, 16384
    v_add_f32 v192, v192, v208
    v_add_f32 v193, v193, v209
    v_add_f32 v194, v194, v210
    v_add_f32 v195, v195, v211
    v_add_f32 v196, v196, v212
    v_add_f32 v197, v197, v213
    v_add_f32 v198, v198, v214
    v_add_f32 v199, v199, v215
    v_cvt_pk_bf16_f32 v200, v192, v193
    v_cvt_pk_bf16_f32 v201, v194, v195
    v_cvt_pk_bf16_f32 v202, v196, v197
    v_cvt_pk_bf16_f32 v203, v198, v199
    s_waitcnt vmcnt(5)
    s_add_u32 m0, s56, 20480
    s_nop 0
    buffer_load_dwordx4 v2, s[44:47], s52 offen offset:0 nt lds
    v_cmp_eq_u32 vcc, 0, v12
    s_nop 1
    v_cndmask_b32 v32, 0, v200, vcc
    v_cndmask_b32 v33, 0, v201, vcc
    v_cndmask_b32 v34, 0, v202, vcc
    v_cndmask_b32 v35, 0, v203, vcc
    v_cmp_eq_u32 vcc, 1, v12
    s_nop 1
    v_cndmask_b32 v36, 0, v200, vcc
    v_cndmask_b32 v37, 0, v201, vcc
    v_cndmask_b32 v38, 0, v202, vcc
    v_cndmask_b32 v39, 0, v203, vcc
    v_cmp_eq_u32 vcc, 2, v12
    s_nop 1
    v_cndmask_b32 v40, 0, v200, vcc
    v_cndmask_b32 v41, 0, v201, vcc
    v_cndmask_b32 v42, 0, v202, vcc
    v_cndmask_b32 v43, 0, v203, vcc
    v_cmp_eq_u32 vcc, 3, v12
    s_nop 1
    v_cndmask_b32 v44, 0, v200, vcc
    v_cndmask_b32 v45, 0, v201, vcc
    v_cndmask_b32 v46, 0, v202, vcc
    v_cndmask_b32 v47, 0, v203, vcc
    s_waitcnt vmcnt(5)
    buffer_load_dwordx4 v2, s[44:47], s52 offen offset:1024 nt lds
    s_nop 1
    v_mfma_f32_16x16x32_bf16 v[16:19], v[64:67], v[32:35], 0
    s_cmp_eq_u32 s57, 0
    s_cbranch_scc1 L_th1
    s_waitcnt vmcnt(5)
    s_cmp_lg_u32 s57, 2
    s_cbranch_scc1 L_th1
    s_waitcnt vmcnt(4)
L_th1:
    buffer_load_dwordx4 v2, s[44:47], s52 offen offset:2048 nt lds
    v_mfma_f32_16x16x32_bf16 v[16:19], v[68:71], v[36:39], v[16:19]
    s_waitcnt vmcnt(6)
    s_cmp_eq_u32 s57, 0
    s_cbranch_scc1 L_th2
    s_waitcnt vmcnt(5)
    s_cmp_lg_u32 s57, 2
    s_cbranch_scc1 L_th2
    s_waitcnt vmcnt(4)
L_th2:
    buffer_load_dwordx4 v2, s[44:47], s52 offen offset:3072 nt lds
    s_add_u32 s52, s52, 16384
    v_mfma_f32_16x16x32_bf16 v[16:19], v[72:75], v[40:43], v[16:19]
    s_waitcnt vmcnt(6)
    s_cmp_eq_u32 s57, 0
    s_cbranch_scc1 L_th3
    s_waitcnt vmcnt(5)
    s_cmp_lg_u32 s57, 2
    s_cbranch_scc1 L_th3
    s_waitcnt vmcnt(4)
L_th3:
    buffer_load_dwordx4 v[64:67], v2, s[44:47], s52 offen offset:0 nt
    s_waitcnt lgkmcnt(0)
    v_readfirstlane_b32 s57, v51
    v_add_u32 v48, 1, v48
    ds_write_b32 v49, v48
    ds_read_b32 v51, v50
    v_mfma_f32_16x16x32_bf16 v[16:19], v[76:79], v[44:47], v[16:19]
    s_nop 7
    v_add_f32_dpp v11, v18, v16 row_ror:8 row_mask:0xf bank_mask:0xf
    v_add_f32_dpp v12, v19, v17 row_ror:8 row_mask:0xf bank_mask:0xf
    s_nop 1
    v_add_f32_dpp v10, v12, v11 row_ror:12 row_mask:0xf bank_mask:0x1
    v_mfma_f32_16x16x32_bf16 v[16:19], v[80:83], v[32:35], 0
    s_waitcnt vmcnt(6)
    s_cmp_eq_u32 s57, 0
    s_cbranch_scc1 L_th4
    s_waitcnt vmcnt(5)
    s_cmp_lg_u32 s57, 2
    s_cbranch_scc1 L_th4
    s_waitcnt vmcnt(4)
L_th4:
    buffer_load_dwordx4 v[68:71], v2, s[44:47], s52 offen offset:1024 nt
    v_mfma_f32_16x16x32_bf16 v[16:19], v[84:87], v[36:39], v[16:19]
    v_mfma_f32_16x16x32_bf16 v[16:19], v[88:91], v[40:43], v[16:19]
    s_waitcnt vmcnt(6)
    s_cmp_eq_u32 s57, 0
    s_cbranch_scc1 L_th5
    s_waitcnt vmcnt(5)
    s_cmp_lg_u32 s57, 2
    s_cbranch_scc1 L_th5
    s_waitcnt vmcnt(4)
L_th5:
    buffer_load_dwordx4 v[72:75], v2, s[44:47], s52 offen offset:2048 nt
    v_mfma_f32_16x16x32_bf16 v[16:19], v[92:95], v[44:47], v[16:19]
    s_nop 7
    v_add_f32_dpp v11, v19, v17 row_ror:8 row_mask:0xf bank_mask:0xf
    v_add_f32_dpp v12, v18, v16 row_ror:8 row_mask:0xf bank_mask:0xf
    s_nop 1
    v_add_f32_dpp v10, v12, v11 row_ror:4 row_mask:0xf bank_mask:0x2
    v_mfma_f32_16x16x32_bf16 v[16:19], v[96:99], v[32:35], 0
    s_waitcnt vmcnt(6)
    s_cmp_eq_u32 s57, 0
    s_cbranch_scc1 L_th6
    s_waitcnt vmcnt(5)
    s_cmp_lg_u32 s57, 2
    s_cbranch_scc1 L_th6
    s_waitcnt vmcnt(4)
L_th6:
    buffer_load_dwordx4 v[76:79], v2, s[44:47], s52 offen offset:3072 nt
    s_add_u32 s52, s52, 16384
    v_mfma_f32_16x16x32_bf16 v[16:19], v[100:103], v[36:39], v[16:19]
    v_mfma_f32_16x16x32_bf16 v[16:19], v[104:107], v[40:43], v[16:19]
    s_waitcnt vmcnt(6)
    s_cmp_eq_u32 s57, 0
    s_cbranch_scc1 L_th7
    s_waitcnt vmcnt(5)
    s_cmp_lg_u32 s57, 2
    s_cbranch_scc1 L_th7
    s_waitcnt vmcnt(4)
L_th7:
    buffer_load_dwordx4 v[80:83], v2, s[44:47], s52 offen offset:0 nt
    s_waitcnt lgkmcnt(0)
    v_readfirstlane_b32 s57, v51
    v_add_u32 v48, 1, v48
    ds_write_b32 v49, v48
    ds_read_b32 v51, v50
    v_mfma_f32_16x16x32_bf16 v[16:19], v[108:111], v[44:47], v[16:19]
    s_nop 7
    v_add_f32_dpp v11, v16, v18 row_ror:8 row_mask:0xf bank_mask:0xf
    v_add_f32_dpp v12, v17, v19 row_ror:8 row_mask:0xf bank_mask:0xf
    s_nop 1
    v_add_f32_dpp v10, v12, v11 row_ror:12 row_mask:0xf bank_mask:0x4
    v_mfma_f32_16x16x32_bf16 v[16:19], v[112:115], v[32:35], 0
    s_waitcnt vmcnt(6)
    s_cmp_eq_u32 s57, 0
    s_cbranch_scc1 L_th8
    s_waitcnt vmcnt(5)
    s_cmp_lg_u32 s57, 2
    s_cbranch_scc1 L_th8
    s_waitcnt vmcnt(4)
L_th8:
    buffer_load_dwordx4 v[84:87], v2, s[44:47], s52 offen offset:1024 nt
    v_mfma_f32_16x16x32_bf16 v[16:19], v[116:119], v[36:39], v[16:19]
    v_mfma_f32_16x16x32_bf16 v[16:19], v[120:123], v[40:43], v[16:19]
    s_waitcnt vmcnt(6)
    s_cmp_eq_u32 s57, 0
    s_cbranch_scc1 L_th9
    s_waitcnt vmcnt(5)
    s_cmp_lg_u32 s57, 2
    s_cbranch_scc1 L_th9
    s_waitcnt vmcnt(4)
L_th9:
    buffer_load_dwordx4 v[88:91], v2, s[44:47], s52 offen offset:2048 nt
    v_mfma_f32_16x16x32_bf16 v[16:19], v[124:127], v[44:47], v[16:19]
    s_nop 7
    v_add_f32_dpp v11, v17, v19 row_ror:8 row_mask:0xf bank_mask:0xf
    v_add_f32_dpp v12, v16, v18 row_ror:8 row_mask:0xf bank_mask:0xf
    s_nop 1
    v_add_f32_dpp v10, v12, v11 row_ror:4 row_mask:0xf bank_mask:0x8
    v_cvt_pk_bf16_f32 v13, v10, v10
    v_and_b32 v13, 0xffff0000, v13
    v_mul_f32 v13, 0x3db504f3, v13
    v_cvt_pk_bf16_f32 v13, v13, v13
    v_and_b32 v13, 0xffff0000, v13
    ds_write_b32 v28, v13 offset:0
    v_max_f32 v14, v8, v13
    v_sub_f32 v11, v8, v14
    v_sub_f32 v12, v13, v14
    v_mul_f32 v11, 0x3fb8aa3b, v11
    v_mul_f32 v12, 0x3fb8aa3b, v12
    v_exp_f32 v11, v11
    v_exp_f32 v12, v12
    v_mov_b32 v8, v14
    v_fma_f32 v9, v9, v11, v12
    v_mfma_f32_16x16x32_bf16 v[16:19], v[128:131], v[32:35], 0
    s_waitcnt vmcnt(6)
    s_cmp_eq_u32 s57, 0
    s_cbranch_scc1 L_th10
    s_waitcnt vmcnt(5)
    s_cmp_lg_u32 s57, 2
    s_cbranch_scc1 L_th10
    s_waitcnt vmcnt(4)
L_th10:
    buffer_load_dwordx4 v[92:95], v2, s[44:47], s52 offen offset:3072 nt
    s_add_u32 s52, s52, 16384
    v_mfma_f32_16x16x32_bf16 v[16:19], v[132:135], v[36:39], v[16:19]
    v_mfma_f32_16x16x32_bf16 v[16:19], v[136:139], v[40:43], v[16:19]
    s_waitcnt vmcnt(6)
    s_cmp_eq_u32 s57, 0
    s_cbranch_scc1 L_th11
    s_waitcnt vmcnt(5)
    s_cmp_lg_u32 s57, 2
    s_cbranch_scc1 L_th11
    s_waitcnt vmcnt(4)
L_th11:
    buffer_load_dwordx4 v[96:99], v2, s[44:47], s52 offen offset:0 nt
    s_waitcnt lgkmcnt(0)
    v_readfirstlane_b32 s57, v51
    v_add_u32 v48, 1, v48
    ds_write_b32 v49, v48
    ds_read_b32 v51, v50
    v_mfma_f32_16x16x32_bf16 v[16:19], v[140:143], v[44:47], v[16:19]
    s_nop 7
    v_add_f32_dpp v11, v18, v16 row_ror:8 row_mask:0xf bank_mask:0xf
    v_add_f32_dpp v12, v19, v17 row_ror:8 row_mask:0xf bank_mask:0xf
    s_nop 1
    v_add_f32_dpp v10, v12, v11 row_ror:12 row_mask:0xf bank_mask:0x1
    v_mfma_f32_16x16x32_bf16 v[16:19], v[144:147], v[32:35], 0
    s_waitcnt vmcnt(6)
    s_cmp_eq_u32 s57, 0
    s_cbranch_scc1 L_th12
    s_waitcnt vmcnt(5)
    s_cmp_lg_u32 s57, 2
    s_cbranch_scc1 L_th12
    s_waitcnt vmcnt(4)
L_th12:
    buffer_load_dwordx4 v[100:103], v2, s[44:47], s52 offen offset:1024 nt
    v_mfma_f32_16x16x32_bf16 v[16:19], v[148:151], v[36:39], v[16:19]
    v_mfma_f32_16x16x32_bf16 v[16:19], v[152:155], v[40:43], v[16:19]
    s_waitcnt vmcnt(6)
    s_cmp_eq_u32 s57, 0
    s_cbranch_scc1 L_th13
    s_waitcnt vmcnt(5)
    s_cmp_lg_u32 s57, 2
    s_cbranch_scc1 L_th13
    s_waitcnt vmcnt(4)
L_th13:
    buffer_load_dwordx4 v[104:107], v2, s[44:47], s52 offen offset:2048 nt
    v_mfma_f32_16x16x32_bf16 v[16:19], v[156:159], v[44:47], v[16:19]
    s_nop 7
    v_add_f32_dpp v11, v19, v17 row_ror:8 row_mask:0xf bank_mask:0xf
    v_add_f32_dpp v12, v18, v16 row_ror:8 row_mask:0xf bank_mask:0xf
    s_nop 1
    v_add_f32_dpp v10, v12, v11 row_ror:4 row_mask:0xf bank_mask:0x2
    v_mfma_f32_16x16x32_bf16 v[16:19], v[160:163], v[32:35], 0
    s_waitcnt vmcnt(6)
    s_cmp_eq_u32 s57, 0
    s_cbranch_scc1 L_th14
    s_waitcnt vmcnt(5)
    s_cmp_lg_u32 s57, 2
    s_cbranch_scc1 L_th14
    s_waitcnt vmcnt(4)
L_th14:
    buffer_load_dwordx4 v[108:111], v2, s[44:47], s52 offen offset:3072 nt
    s_add_u32 s52, s52, 16384
    v_mfma_f32_16x16x32_bf16 v[16:19], v[164:167], v[36:39], v[16:19]
    v_mfma_f32_16x16x32_bf16 v[16:19], v[168:171], v[40:43], v[16:19]
    s_waitcnt vmcnt(6)
    s_cmp_eq_u32 s57, 0
    s_cbranch_scc1 L_th15
    s_waitcnt vmcnt(5)
    s_cmp_lg_u32 s57, 2
    s_cbranch_scc1 L_th15
    s_waitcnt vmcnt(4)
L_th15:
    buffer_load_dwordx4 v[112:115], v2, s[44:47], s52 offen offset:0 nt
    s_waitcnt lgkmcnt(0)
    v_readfirstlane_b32 s57, v51
    v_add_u32 v48, 1, v48
    ds_write_b32 v49, v48
    ds_read_b32 v51, v50
    v_mfma_f32_16x16x32_bf16 v[16:19], v[172:175], v[44:47], v[16:19]
    s_nop 7
    v_add_f32_dpp v11, v16, v18 row_ror:8 row_mask:0xf bank_mask:0xf
    v_add_f32_dpp v12, v17, v19 row_ror:8 row_mask:0xf bank_mask:0xf
    s_nop 1
    v_add_f32_dpp v10, v12, v11 row_ror:12 row_mask:0xf bank_mask:0x4
    ds_read_b128 v[192:195], v31 offset:0
    ds_read_b128 v[196:199], v31 offset:1024
    ds_read_b128 v[200:203], v31 offset:2048
    ds_read_b128 v[204:207], v31 offset:3072
    v_mfma_f32_16x16x32_bf16 v[16:19], v[176:179], v[32:35], 0
    s_waitcnt vmcnt(6)
    s_cmp_eq_u32 s57, 0
    s_cbranch_scc1 L_th16
    s_waitcnt vmcnt(5)
    s_cmp_lg_u32 s57, 2
    s_cbranch_scc1 L_th16
    s_waitcnt vmcnt(4)
L_th16:
    buffer_load_dwordx4 v[116:119], v2, s[44:47], s52 offen offset:1024 nt
    v_mfma_f32_16x16x32_bf16 v[16:19], v[180:183], v[36:39], v[16:19]
    v_mfma_f32_16x16x32_bf16 v[16:19], v[184:187], v[40:43], v[16:19]
    s_waitcnt vmcnt(6)
    s_cmp_eq_u32 s57, 0
    s_cbranch_scc1 L_th17
    s_waitcnt vmcnt(5)
    s_cmp_lg_u32 s57, 2
    s_cbranch_scc1 L_th17
    s_waitcnt vmcnt(4)
L_th17:
    buffer_load_dwordx4 v[120:123], v2, s[44:47], s52 offen offset:2048 nt
    v_mfma_f32_16x16x32_bf16 v[16:19], v[188:191], v[44:47], v[16:19]
    s_nop 7
    v_add_f32_dpp v11, v17, v19 row_ror:8 row_mask:0xf bank_mask:0xf
    v_add_f32_dpp v12, v16, v18 row_ror:8 row_mask:0xf bank_mask:0xf
    s_nop 1
    v_add_f32_dpp v10, v12, v11 row_ror:4 row_mask:0xf bank_mask:0x8
    v_cvt_pk_bf16_f32 v13, v10, v10
    v_and_b32 v13, 0xffff0000, v13
    v_mul_f32 v13, 0x3db504f3, v13
    v_cvt_pk_bf16_f32 v13, v13, v13
    v_and_b32 v13, 0xffff0000, v13
    ds_write_b32 v28, v13 offset:256
    v_max_f32 v14, v8, v13
    v_sub_f32 v11, v8, v14
    v_sub_f32 v12, v13, v14
    v_mul_f32 v11, 0x3fb8aa3b, v11
    v_mul_f32 v12, 0x3fb8aa3b, v12
    v_exp_f32 v11, v11
    v_exp_f32 v12, v12
    v_mov_b32 v8, v14
    v_fma_f32 v9, v9, v11, v12
    v_add_u32 v28, 512, v28
    s_waitcnt lgkmcnt(0)
    ds_read_b128 v[208:211], v31 offset:4096
    ds_read_b128 v[212:215], v31 offset:5120
    ds_read_b128 v[216:219], v31 offset:6144
    ds_read_b128 v[220:223], v31 offset:7168
    v_mfma_f32_16x16x32_bf16 v[16:19], v[192:195], v[32:35], 0
    s_waitcnt vmcnt(6)
    s_cmp_eq_u32 s57, 0
    s_cbranch_scc1 L_th18
    s_waitcnt vmcnt(5)
    s_cmp_lg_u32 s57, 2
    s_cbranch_scc1 L_th18
    s_waitcnt vmcnt(4)
L_th18:
    buffer_load_dwordx4 v[124:127], v2, s[44:47], s52 offen offset:3072 nt
    s_add_u32 s52, s52, 16384
    v_mfma_f32_16x16x32_bf16 v[16:19], v[196:199], v[36:39], v[16:19]
    v_mfma_f32_16x16x32_bf16 v[16:19], v[200:203], v[40:43], v[16:19]
    s_waitcnt vmcnt(6)
    s_cmp_eq_u32 s57, 0
    s_cbranch_scc1 L_th19
    s_waitcnt vmcnt(5)
    s_cmp_lg_u32 s57, 2
    s_cbranch_scc1 L_th19
    s_waitcnt vmcnt(4)
L_th19:
    buffer_load_dwordx4 v[128:131], v2, s[44:47], s52 offen offset:0 nt
    s_waitcnt lgkmcnt(0)
    v_readfirstlane_b32 s57, v51
    v_add_u32 v48, 1, v48
    ds_write_b32 v49, v48
    ds_read_b32 v51, v50
    v_mfma_f32_16x16x32_bf16 v[16:19], v[204:207], v[44:47], v[16:19]
    s_nop 7
    v_add_f32_dpp v11, v18, v16 row_ror:8 row_mask:0xf bank_mask:0xf
    v_add_f32_dpp v12, v19, v17 row_ror:8 row_mask:0xf bank_mask:0xf
    s_nop 1
    v_add_f32_dpp v10, v12, v11 row_ror:12 row_mask:0xf bank_mask:0x1
    s_waitcnt lgkmcnt(0)
    ds_read_b128 v[192:195], v31 offset:8192
    ds_read_b128 v[196:199], v31 offset:9216
    ds_read_b128 v[200:203], v31 offset:10240
    ds_read_b128 v[204:207], v31 offset:11264
    v_mfma_f32_16x16x32_bf16 v[16:19], v[208:211], v[32:35], 0
    s_waitcnt vmcnt(6)
    s_cmp_eq_u32 s57, 0
    s_cbranch_scc1 L_th20
    s_waitcnt vmcnt(5)
    s_cmp_lg_u32 s57, 2
    s_cbranch_scc1 L_th20
    s_waitcnt vmcnt(4)
L_th20:
    buffer_load_dwordx4 v[132:135], v2, s[44:47], s52 offen offset:1024 nt
    v_mfma_f32_16x16x32_bf16 v[16:19], v[212:215], v[36:39], v[16:19]
    v_mfma_f32_16x16x32_bf16 v[16:19], v[216:219], v[40:43], v[16:19]
    s_waitcnt vmcnt(6)
    s_cmp_eq_u32 s57, 0
    s_cbranch_scc1 L_th21
    s_waitcnt vmcnt(5)
    s_cmp_lg_u32 s57, 2
    s_cbranch_scc1 L_th21
    s_waitcnt vmcnt(4)
L_th21:
    buffer_load_dwordx4 v[136:139], v2, s[44:47], s52 offen offset:2048 nt
    v_mfma_f32_16x16x32_bf16 v[16:19], v[220:223], v[44:47], v[16:19]
    s_nop 7
    v_add_f32_dpp v11, v19, v17 row_ror:8 row_mask:0xf bank_mask:0xf
    v_add_f32_dpp v12, v18, v16 row_ror:8 row_mask:0xf bank_mask:0xf
    s_nop 1
    v_add_f32_dpp v10, v12, v11 row_ror:4 row_mask:0xf bank_mask:0x2
    s_waitcnt lgkmcnt(0)
    ds_read_b128 v[208:211], v31 offset:12288
    ds_read_b128 v[212:215], v31 offset:13312
    ds_read_b128 v[216:219], v31 offset:14336
    ds_read_b128 v[220:223], v31 offset:15360
    v_mfma_f32_16x16x32_bf16 v[16:19], v[192:195], v[32:35], 0
    s_waitcnt vmcnt(6)
    s_cmp_eq_u32 s57, 0
    s_cbranch_scc1 L_th22
    s_waitcnt vmcnt(5)
    s_cmp_lg_u32 s57, 2
    s_cbranch_scc1 L_th22
    s_waitcnt vmcnt(4)
L_th22:
    buffer_load_dwordx4 v[140:143], v2, s[44:47], s52 offen offset:3072 nt
    s_add_u32 s52, s52, 16384
    v_mfma_f32_16x16x32_bf16 v[16:19], v[196:199], v[36:39], v[16:19]
    v_mfma_f32_16x16x32_bf16 v[16:19], v[200:203], v[40:43], v[16:19]
    s_waitcnt vmcnt(6)
    s_cmp_eq_u32 s57, 0
    s_cbranch_scc1 L_th23
    s_waitcnt vmcnt(5)
    s_cmp_lg_u32 s57, 2
    s_cbranch_scc1 L_th23
    s_waitcnt vmcnt(4)
L_th23:
    buffer_load_dwordx4 v[144:147], v2, s[44:47], s52 offen offset:0 nt
    s_waitcnt lgkmcnt(0)
    v_readfirstlane_b32 s57, v51
    v_add_u32 v48, 1, v48
    ds_write_b32 v49, v48
    ds_read_b32 v51, v50
    v_mfma_f32_16x16x32_bf16 v[16:19], v[204:207], v[44:47], v[16:19]
    s_nop 7
    v_add_f32_dpp v11, v16, v18 row_ror:8 row_mask:0xf bank_mask:0xf
    v_add_f32_dpp v12, v17, v19 row_ror:8 row_mask:0xf bank_mask:0xf
    s_nop 1
    v_add_f32_dpp v10, v12, v11 row_ror:12 row_mask:0xf bank_mask:0x4
    s_waitcnt lgkmcnt(0)
    ds_read_b128 v[192:195], v31 offset:16384
    ds_read_b128 v[196:199], v31 offset:17408
    ds_read_b128 v[200:203], v31 offset:18432
    ds_read_b128 v[204:207], v31 offset:19456
    v_mfma_f32_16x16x32_bf16 v[16:19], v[208:211], v[32:35], 0
    s_waitcnt vmcnt(6)
    s_cmp_eq_u32 s57, 0
    s_cbranch_scc1 L_th24
    s_waitcnt vmcnt(5)
    s_cmp_lg_u32 s57, 2
    s_cbranch_scc1 L_th24
    s_waitcnt vmcnt(4)
L_th24:
    buffer_load_dwordx4 v[148:151], v2, s[44:47], s52 offen offset:1024 nt
    v_mfma_f32_16x16x32_bf16 v[16:19], v[212:215], v[36:39], v[16:19]
    v_mfma_f32_16x16x32_bf16 v[16:19], v[216:219], v[40:43], v[16:19]
    s_waitcnt vmcnt(6)
    s_cmp_eq_u32 s57, 0
    s_cbranch_scc1 L_th25
    s_waitcnt vmcnt(5)
    s_cmp_lg_u32 s57, 2
    s_cbranch_scc1 L_th25
    s_waitcnt vmcnt(4)
L_th25:
    buffer_load_dwordx4 v[152:155], v2, s[44:47], s52 offen offset:2048 nt
    v_mfma_f32_16x16x32_bf16 v[16:19], v[220:223], v[44:47], v[16:19]
    s_nop 7
    v_add_f32_dpp v11, v17, v19 row_ror:8 row_mask:0xf bank_mask:0xf
    v_add_f32_dpp v12, v16, v18 row_ror:8 row_mask:0xf bank_mask:0xf
    s_nop 1
    v_add_f32_dpp v10, v12, v11 row_ror:4 row_mask:0xf bank_mask:0x8
    v_cvt_pk_bf16_f32 v13, v10, v10
    v_and_b32 v13, 0xffff0000, v13
    v_mul_f32 v13, 0x3db504f3, v13
    v_cvt_pk_bf16_f32 v13, v13, v13
    v_and_b32 v13, 0xffff0000, v13
    ds_write_b32 v28, v13 offset:0
    v_max_f32 v14, v8, v13
    v_sub_f32 v11, v8, v14
    v_sub_f32 v12, v13, v14
    v_mul_f32 v11, 0x3fb8aa3b, v11
    v_mul_f32 v12, 0x3fb8aa3b, v12
    v_exp_f32 v11, v11
    v_exp_f32 v12, v12
    v_mov_b32 v8, v14
    v_fma_f32 v9, v9, v11, v12
    s_waitcnt lgkmcnt(0)
    ds_read_b128 v[208:211], v31 offset:20480
    ds_read_b128 v[212:215], v31 offset:21504
    ds_read_b128 v[216:219], v31 offset:22528
    ds_read_b128 v[220:223], v31 offset:23552
    v_mfma_f32_16x16x32_bf16 v[16:19], v[192:195], v[32:35], 0
    s_waitcnt vmcnt(6)
    s_cmp_eq_u32 s57, 0
    s_cbranch_scc1 L_th26
    s_waitcnt vmcnt(5)
    s_cmp_lg_u32 s57, 2
    s_cbranch_scc1 L_th26
    s_waitcnt vmcnt(4)
L_th26:
    buffer_load_dwordx4 v[156:159], v2, s[44:47], s52 offen offset:3072 nt
    s_add_u32 s52, s52, 16384
    v_mfma_f32_16x16x32_bf16 v[16:19], v[196:199], v[36:39], v[16:19]
    s_waitcnt vmcnt(6)
    s_cmp_eq_u32 s57, 0
    s_cbranch_scc1 L_th27
    s_waitcnt vmcnt(5)
    s_cmp_lg_u32 s57, 2
    s_cbranch_scc1 L_th27
    s_waitcnt vmcnt(4)
L_th27:
    buffer_load_dwordx4 v[160:163], v2, s[44:47], s52 offen offset:0 nt
    s_waitcnt lgkmcnt(0)
    v_readfirstlane_b32 s57, v51
    v_add_u32 v48, 1, v48
    ds_write_b32 v49, v48
    ds_read_b32 v51, v50
    v_mfma_f32_16x16x32_bf16 v[16:19], v[200:203], v[40:43], v[16:19]
    v_mfma_f32_16x16x32_bf16 v[16:19], v[204:207], v[44:47], v[16:19]
    s_waitcnt vmcnt(6)
    s_cmp_eq_u32 s57, 0
    s_cbranch_scc1 L_th28
    s_waitcnt vmcnt(5)
    s_cmp_lg_u32 s57, 2
    s_cbranch_scc1 L_th28
    s_waitcnt vmcnt(4)
L_th28:
    buffer_load_dwordx4 v[164:167], v2, s[44:47], s52 offen offset:1024 nt
    s_nop 7
    v_add_f32_dpp v11, v18, v16 row_ror:8 row_mask:0xf bank_mask:0xf
    v_add_f32_dpp v12, v19, v17 row_ror:8 row_mask:0xf bank_mask:0xf
    s_nop 1
    v_add_f32_dpp v10, v12, v11 row_ror:12 row_mask:0xf bank_mask:0x1
    s_waitcnt lgkmcnt(0)
    v_mfma_f32_16x16x32_bf16 v[16:19], v[208:211], v[32:35], 0
    v_mfma_f32_16x16x32_bf16 v[16:19], v[212:215], v[36:39], v[16:19]
    s_waitcnt vmcnt(6)
    s_cmp_eq_u32 s57, 0
    s_cbranch_scc1 L_th29
    s_waitcnt vmcnt(5)
    s_cmp_lg_u32 s57, 2
    s_cbranch_scc1 L_th29
    s_waitcnt vmcnt(4)
L_th29:
    buffer_load_dwordx4 v[168:171], v2, s[44:47], s52 offen offset:2048 nt
    v_mfma_f32_16x16x32_bf16 v[16:19], v[216:219], v[40:43], v[16:19]
    v_mfma_f32_16x16x32_bf16 v[16:19], v[220:223], v[44:47], v[16:19]
    s_waitcnt vmcnt(6)
    s_cmp_eq_u32 s57, 0
    s_cbranch_scc1 L_th30
    s_waitcnt vmcnt(5)
    s_cmp_lg_u32 s57, 2
    s_cbranch_scc1 L_th30
    s_waitcnt vmcnt(4)
L_th30:
    buffer_load_dwordx4 v[172:175], v2, s[44:47], s52 offen offset:3072 nt
    s_add_u32 s52, s52, 16384
    s_nop 7
    v_add_f32_dpp v11, v19, v17 row_ror:8 row_mask:0xf bank_mask:0xf
    v_add_f32_dpp v12, v18, v16 row_ror:8 row_mask:0xf bank_mask:0xf
    s_nop 1
    v_add_f32_dpp v10, v12, v11 row_ror:4 row_mask:0xf bank_mask:0x2
    v_mfma_f32_16x16x32_bf16 v[16:19], v[64:67], v[32:35], 0
    v_mfma_f32_16x16x32_bf16 v[16:19], v[68:71], v[36:39], v[16:19]
    s_waitcnt vmcnt(6)
    s_cmp_eq_u32 s57, 0
    s_cbranch_scc1 L_th31
    s_waitcnt vmcnt(5)
    s_cmp_lg_u32 s57, 2
    s_cbranch_scc1 L_th31
    s_waitcnt vmcnt(4)
L_th31:
    buffer_load_dwordx4 v[176:179], v2, s[44:47], s52 offen offset:0 nt
    s_waitcnt lgkmcnt(0)
    v_readfirstlane_b32 s57, v51
    v_add_u32 v48, 1, v48
    ds_write_b32 v49, v48
    ds_read_b32 v51, v50
    v_mfma_f32_16x16x32_bf16 v[16:19], v[72:75], v[40:43], v[16:19]
    v_mfma_f32_16x16x32_bf16 v[16:19], v[76:79], v[44:47], v[16:19]
    s_waitcnt vmcnt(6)
    s_cmp_eq_u32 s57, 0
    s_cbranch_scc1 L_th32
    s_waitcnt vmcnt(5)
    s_cmp_lg_u32 s57, 2
    s_cbranch_scc1 L_th32
    s_waitcnt vmcnt(4)
L_th32:
    buffer_load_dwordx4 v[180:183], v2, s[44:47], s52 offen offset:1024 nt
    s_nop 7
    v_add_f32_dpp v11, v16, v18 row_ror:8 row_mask:0xf bank_mask:0xf
    v_add_f32_dpp v12, v17, v19 row_ror:8 row_mask:0xf bank_mask:0xf
    s_nop 1
    v_add_f32_dpp v10, v12, v11 row_ror:12 row_mask:0xf bank_mask:0x4
    v_mfma_f32_16x16x32_bf16 v[16:19], v[80:83], v[32:35], 0
    v_mfma_f32_16x16x32_bf16 v[16:19], v[84:87], v[36:39], v[16:19]
    s_waitcnt vmcnt(6)
    s_cmp_eq_u32 s57, 0
    s_cbranch_scc1 L_th33
    s_waitcnt vmcnt(5)
    s_cmp_lg_u32 s57, 2
    s_cbranch_scc1 L_th33
    s_waitcnt vmcnt(4)
L_th33:
    buffer_load_dwordx4 v[184:187], v2, s[44:47], s52 offen offset:2048 nt
    v_mfma_f32_16x16x32_bf16 v[16:19], v[88:91], v[40:43], v[16:19]
    v_mfma_f32_16x16x32_bf16 v[16:19], v[92:95], v[44:47], v[16:19]
    s_waitcnt vmcnt(6)
    s_cmp_eq_u32 s57, 0
    s_cbranch_scc1 L_th34
    s_waitcnt vmcnt(5)
    s_cmp_lg_u32 s57, 2
    s_cbranch_scc1 L_th34
    s_waitcnt vmcnt(4)
L_th34:
    buffer_load_dwordx4 v[188:191], v2, s[44:47], s52 offen offset:3072 nt
    s_add_u32 s52, s52, 16384
    s_nop 7
    v_add_f32_dpp v11, v17, v19 row_ror:8 row_mask:0xf bank_mask:0xf
    v_add_f32_dpp v12, v16, v18 row_ror:8 row_mask:0xf bank_mask:0xf
    s_nop 1
    v_add_f32_dpp v10, v12, v11 row_ror:4 row_mask:0xf bank_mask:0x8
    v_cvt_pk_bf16_f32 v13, v10, v10
    v_and_b32 v13, 0xffff0000, v13
    v_mul_f32 v13, 0x3db504f3, v13
    v_cvt_pk_bf16_f32 v13, v13, v13
    v_and_b32 v13, 0xffff0000, v13
    ds_write_b32 v28, v13 offset:256
    v_max_f32 v14, v8, v13
    v_sub_f32 v11, v8, v14
    v_sub_f32 v12, v13, v14
    v_mul_f32 v11, 0x3fb8aa3b, v11
    v_mul_f32 v12, 0x3fb8aa3b, v12
    v_exp_f32 v11, v11
    v_exp_f32 v12, v12
    v_mov_b32 v8, v14
    v_fma_f32 v9, v9, v11, v12
    v_add_u32 v28, 512, v28
    v_mfma_f32_16x16x32_bf16 v[16:19], v[96:99], v[32:35], 0
    v_mfma_f32_16x16x32_bf16 v[16:19], v[100:103], v[36:39], v[16:19]
    s_waitcnt vmcnt(6)
    s_cmp_eq_u32 s57, 0
    s_cbranch_scc1 L_th35
    s_waitcnt vmcnt(5)
    s_cmp_lg_u32 s57, 2
    s_cbranch_scc1 L_th35
    s_waitcnt vmcnt(4)
L_th35:
    buffer_load_dwordx4 v[64:67], v2, s[44:47], s52 offen offset:0 nt
    s_waitcnt lgkmcnt(0)
    v_readfirstlane_b32 s57, v51
    v_add_u32 v48, 1, v48
    ds_write_b32 v49, v48
    ds_read_b32 v51, v50
    v_mfma_f32_16x16x32_bf16 v[16:19], v[104:107], v[40:43], v[16:19]
    v_mfma_f32_16x16x32_bf16 v[16:19], v[108:111], v[44:47], v[16:19]
    s_waitcnt vmcnt(6)
    s_cmp_eq_u32 s57, 0
    s_cbranch_scc1 L_th36
    s_waitcnt vmcnt(5)
    s_cmp_lg_u32 s57, 2
    s_cbranch_scc1 L_th36
    s_waitcnt vmcnt(4)
L_th36:
    buffer_load_dwordx4 v[68:71], v2, s[44:47], s52 offen offset:1024 nt
    s_nop 7
    v_add_f32_dpp v11, v18, v16 row_ror:8 row_mask:0xf bank_mask:0xf
    v_add_f32_dpp v12, v19, v17 row_ror:8 row_mask:0xf bank_mask:0xf
    s_nop 1
    v_add_f32_dpp v10, v12, v11 row_ror:12 row_mask:0xf bank_mask:0x1
    v_mfma_f32_16x16x32_bf16 v[16:19], v[112:115], v[32:35], 0
    v_mfma_f32_16x16x32_bf16 v[16:19], v[116:119], v[36:39], v[16:19]
    s_waitcnt vmcnt(6)
    s_cmp_eq_u32 s57, 0
    s_cbranch_scc1 L_th37
    s_waitcnt vmcnt(5)
    s_cmp_lg_u32 s57, 2
    s_cbranch_scc1 L_th37
    s_waitcnt vmcnt(4)
L_th37:
    buffer_load_dwordx4 v[72:75], v2, s[44:47], s52 offen offset:2048 nt
    v_mfma_f32_16x16x32_bf16 v[16:19], v[120:123], v[40:43], v[16:19]
    v_mfma_f32_16x16x32_bf16 v[16:19], v[124:127], v[44:47], v[16:19]
    s_waitcnt vmcnt(6)
    s_cmp_eq_u32 s57, 0
    s_cbranch_scc1 L_th38
    s_waitcnt vmcnt(5)
    s_cmp_lg_u32 s57, 2
    s_cbranch_scc1 L_th38
    s_waitcnt vmcnt(4)
L_th38:
    buffer_load_dwordx4 v[76:79], v2, s[44:47], s52 offen offset:3072 nt
    s_add_u32 s52, s52, 16384
    s_nop 7
    v_add_f32_dpp v11, v19, v17 row_ror:8 row_mask:0xf bank_mask:0xf
    v_add_f32_dpp v12, v18, v16 row_ror:8 row_mask:0xf bank_mask:0xf
    s_nop 1
    v_add_f32_dpp v10, v12, v11 row_ror:4 row_mask:0xf bank_mask:0x2
    v_mfma_f32_16x16x32_bf16 v[16:19], v[128:131], v[32:35], 0
    v_mfma_f32_16x16x32_bf16 v[16:19], v[132:135], v[36:39], v[16:19]
    s_waitcnt vmcnt(6)
    s_cmp_eq_u32 s57, 0
    s_cbranch_scc1 L_th39
    s_waitcnt vmcnt(5)
    s_cmp_lg_u32 s57, 2
    s_cbranch_scc1 L_th39
    s_waitcnt vmcnt(4)
L_th39:
    buffer_load_dwordx4 v[80:83], v2, s[44:47], s52 offen offset:0 nt
    s_waitcnt lgkmcnt(0)
    v_readfirstlane_b32 s57, v51
    v_add_u32 v48, 1, v48
    ds_write_b32 v49, v48
    ds_read_b32 v51, v50
    v_mfma_f32_16x16x32_bf16 v[16:19], v[136:139], v[40:43], v[16:19]
    v_mfma_f32_16x16x32_bf16 v[16:19], v[140:143], v[44:47], v[16:19]
    s_waitcnt vmcnt(6)
    s_cmp_eq_u32 s57, 0
    s_cbranch_scc1 L_th40
    s_waitcnt vmcnt(5)
    s_cmp_lg_u32 s57, 2
    s_cbranch_scc1 L_th40
    s_waitcnt vmcnt(4)
L_th40:
    buffer_load_dwordx4 v[84:87], v2, s[44:47], s52 offen offset:1024 nt
    s_nop 7
    v_add_f32_dpp v11, v16, v18 row_ror:8 row_mask:0xf bank_mask:0xf
    v_add_f32_dpp v12, v17, v19 row_ror:8 row_mask:0xf bank_mask:0xf
    s_nop 1
    v_add_f32_dpp v10, v12, v11 row_ror:12 row_mask:0xf bank_mask:0x4
    v_mfma_f32_16x16x32_bf16 v[16:19], v[144:147], v[32:35], 0
    v_mfma_f32_16x16x32_bf16 v[16:19], v[148:151], v[36:39], v[16:19]
    s_waitcnt vmcnt(6)
    s_cmp_eq_u32 s57, 0
    s_cbranch_scc1 L_th41
    s_waitcnt vmcnt(5)
    s_cmp_lg_u32 s57, 2
    s_cbranch_scc1 L_th41
    s_waitcnt vmcnt(4)
L_th41:
    buffer_load_dwordx4 v[88:91], v2, s[44:47], s52 offen offset:2048 nt
    v_mfma_f32_16x16x32_bf16 v[16:19], v[152:155], v[40:43], v[16:19]
    v_mfma_f32_16x16x32_bf16 v[16:19], v[156:159], v[44:47], v[16:19]
    s_waitcnt vmcnt(6)
    s_cmp_eq_u32 s57, 0
    s_cbranch_scc1 L_th42
    s_waitcnt vmcnt(5)
    s_cmp_lg_u32 s57, 2
    s_cbranch_scc1 L_th42
    s_waitcnt vmcnt(4)
L_th42:
    buffer_load_dwordx4 v[92:95], v2, s[44:47], s52 offen offset:3072 nt
    s_add_u32 s52, s52, 16384
    s_nop 7
    v_add_f32_dpp v11, v17, v19 row_ror:8 row_mask:0xf bank_mask:0xf
    v_add_f32_dpp v12, v16, v18 row_ror:8 row_mask:0xf bank_mask:0xf
    s_nop 1
    v_add_f32_dpp v10, v12, v11 row_ror:4 row_mask:0xf bank_mask:0x8
    v_cvt_pk_bf16_f32 v13, v10, v10
    v_and_b32 v13, 0xffff0000, v13
    v_mul_f32 v13, 0x3db504f3, v13
    v_cvt_pk_bf16_f32 v13, v13, v13
    v_and_b32 v13, 0xffff0000, v13
    ds_write_b32 v28, v13 offset:0
    v_max_f32 v14, v8, v13
    v_sub_f32 v11, v8, v14
    v_sub_f32 v12, v13, v14
    v_mul_f32 v11, 0x3fb8aa3b, v11
    v_mul_f32 v12, 0x3fb8aa3b, v12
    v_exp_f32 v11, v11
    v_exp_f32 v12, v12
    v_mov_b32 v8, v14
    v_fma_f32 v9, v9, v11, v12
    v_mfma_f32_16x16x32_bf16 v[16:19], v[160:163], v[32:35], 0
    v_mfma_f32_16x16x32_bf16 v[16:19], v[164:167], v[36:39], v[16:19]
    s_waitcnt vmcnt(6)
    s_cmp_eq_u32 s57, 0
    s_cbranch_scc1 L_th43
    s_waitcnt vmcnt(5)
    s_cmp_lg_u32 s57, 2
    s_cbranch_scc1 L_th43
    s_waitcnt vmcnt(4)
L_th43:
    buffer_load_dwordx4 v[96:99], v2, s[44:47], s52 offen offset:0 nt
    s_waitcnt lgkmcnt(0)
    v_readfirstlane_b32 s57, v51
    v_add_u32 v48, 1, v48
    ds_write_b32 v49, v48
    ds_read_b32 v51, v50
    v_mfma_f32_16x16x32_bf16 v[16:19], v[168:171], v[40:43], v[16:19]
    v_mfma_f32_16x16x32_bf16 v[16:19], v[172:175], v[44:47], v[16:19]
    s_waitcnt vmcnt(6)
    s_cmp_eq_u32 s57, 0
    s_cbranch_scc1 L_th44
    s_waitcnt vmcnt(5)
    s_cmp_lg_u32 s57, 2
    s_cbranch_scc1 L_th44
    s_waitcnt vmcnt(4)
L_th44:
    buffer_load_dwordx4 v[100:103], v2, s[44:47], s52 offen offset:1024 nt
    s_nop 7
    v_add_f32_dpp v11, v18, v16 row_ror:8 row_mask:0xf bank_mask:0xf
    v_add_f32_dpp v12, v19, v17 row_ror:8 row_mask:0xf bank_mask:0xf
    s_nop 1
    v_add_f32_dpp v10, v12, v11 row_ror:12 row_mask:0xf bank_mask:0x1
    v_mfma_f32_16x16x32_bf16 v[16:19], v[176:179], v[32:35], 0
    v_mfma_f32_16x16x32_bf16 v[16:19], v[180:183], v[36:39], v[16:19]
    s_waitcnt vmcnt(6)
    s_cmp_eq_u32 s57, 0
    s_cbranch_scc1 L_th45
    s_waitcnt vmcnt(5)
    s_cmp_lg_u32 s57, 2
    s_cbranch_scc1 L_th45
    s_waitcnt vmcnt(4)
L_th45:
    buffer_load_dwordx4 v[104:107], v2, s[44:47], s52 offen offset:2048 nt
    v_mfma_f32_16x16x32_bf16 v[16:19], v[184:187], v[40:43], v[16:19]
    v_mfma_f32_16x16x32_bf16 v[16:19], v[188:191], v[44:47], v[16:19]
    s_waitcnt vmcnt(6)
    s_cmp_eq_u32 s57, 0
    s_cbranch_scc1 L_th46
    s_waitcnt vmcnt(5)
    s_cmp_lg_u32 s57, 2
    s_cbranch_scc1 L_th46
    s_waitcnt vmcnt(4)
L_th46:
    buffer_load_dwordx4 v[108:111], v2, s[44:47], s52 offen offset:3072 nt
    s_add_u32 s52, s52, 16384
    s_nop 7
    v_add_f32_dpp v11, v19, v17 row_ror:8 row_mask:0xf bank_mask:0xf
    v_add_f32_dpp v12, v18, v16 row_ror:8 row_mask:0xf bank_mask:0xf
    s_nop 1
    v_add_f32_dpp v10, v12, v11 row_ror:4 row_mask:0xf bank_mask:0x2
    v_mfma_f32_16x16x32_bf16 v[16:19], v[64:67], v[32:35], 0
    v_mfma_f32_16x16x32_bf16 v[16:19], v[68:71], v[36:39], v[16:19]
    s_waitcnt vmcnt(6)
    s_cmp_eq_u32 s57, 0
    s_cbranch_scc1 L_th47
    s_waitcnt vmcnt(5)
    s_cmp_lg_u32 s57, 2
    s_cbranch_scc1 L_th47
    s_waitcnt vmcnt(4)
L_th47:
    buffer_load_dwordx4 v[112:115], v2, s[44:47], s52 offen offset:0 nt
    s_waitcnt lgkmcnt(0)
    v_readfirstlane_b32 s57, v51
    v_add_u32 v48, 1, v48
    ds_write_b32 v49, v48
    ds_read_b32 v51, v50
    v_mfma_f32_16x16x32_bf16 v[16:19], v[72:75], v[40:43], v[16:19]
    v_mfma_f32_16x16x32_bf16 v[16:19], v[76:79], v[44:47], v[16:19]
    s_waitcnt vmcnt(6)
    s_cmp_eq_u32 s57, 0
    s_cbranch_scc1 L_th48
    s_waitcnt vmcnt(5)
    s_cmp_lg_u32 s57, 2
    s_cbranch_scc1 L_th48
    s_waitcnt vmcnt(4)
L_th48:
    buffer_load_dwordx4 v[116:119], v2, s[44:47], s52 offen offset:1024 nt
    s_nop 7
    v_add_f32_dpp v11, v16, v18 row_ror:8 row_mask:0xf bank_mask:0xf
    v_add_f32_dpp v12, v17, v19 row_ror:8 row_mask:0xf bank_mask:0xf
    s_nop 1
    v_add_f32_dpp v10, v12, v11 row_ror:12 row_mask:0xf bank_mask:0x4
    v_mfma_f32_16x16x32_bf16 v[16:19], v[80:83], v[32:35], 0
    v_mfma_f32_16x16x32_bf16 v[16:19], v[84:87], v[36:39], v[16:19]
    s_waitcnt vmcnt(6)
    s_cmp_eq_u32 s57, 0
    s_cbranch_scc1 L_th49
    s_waitcnt vmcnt(5)
    s_cmp_lg_u32 s57, 2
    s_cbranch_scc1 L_th49
    s_waitcnt vmcnt(4)
L_th49:
    buffer_load_dwordx4 v[120:123], v2, s[44:47], s52 offen offset:2048 nt
    v_mfma_f32_16x16x32_bf16 v[16:19], v[88:91], v[40:43], v[16:19]
    v_mfma_f32_16x16x32_bf16 v[16:19], v[92:95], v[44:47], v[16:19]
    s_waitcnt vmcnt(6)
    s_cmp_eq_u32 s57, 0
    s_cbranch_scc1 L_th50
    s_waitcnt vmcnt(5)
    s_cmp_lg_u32 s57, 2
    s_cbranch_scc1 L_th50
    s_waitcnt vmcnt(4)
L_th50:
    buffer_load_dwordx4 v[124:127], v2, s[44:47], s52 offen offset:3072 nt
    s_add_u32 s52, s52, 16384
    s_nop 7
    v_add_f32_dpp v11, v17, v19 row_ror:8 row_mask:0xf bank_mask:0xf
    v_add_f32_dpp v12, v16, v18 row_ror:8 row_mask:0xf bank_mask:0xf
    s_nop 1
    v_add_f32_dpp v10, v12, v11 row_ror:4 row_mask:0xf bank_mask:0x8
    v_cvt_pk_bf16_f32 v13, v10, v10
    v_and_b32 v13, 0xffff0000, v13
    v_mul_f32 v13, 0x3db504f3, v13
    v_cvt_pk_bf16_f32 v13, v13, v13
    v_and_b32 v13, 0xffff0000, v13
    ds_write_b32 v28, v13 offset:256
    v_max_f32 v14, v8, v13
    v_sub_f32 v11, v8, v14
    v_sub_f32 v12, v13, v14
    v_mul_f32 v11, 0x3fb8aa3b, v11
    v_mul_f32 v12, 0x3fb8aa3b, v12
    v_exp_f32 v11, v11
    v_exp_f32 v12, v12
    v_mov_b32 v8, v14
    v_fma_f32 v9, v9, v11, v12
    v_add_u32 v28, 512, v28
    s_mov_b32 s54, 12
L_kloop:
    v_mfma_f32_16x16x32_bf16 v[16:19], v[96:99], v[32:35], 0
    s_waitcnt vmcnt(6)
    s_cmp_eq_u32 s57, 0
    s_cbranch_scc1 L_th51
    s_waitcnt vmcnt(5)
    s_cmp_lg_u32 s57, 2
    s_cbranch_scc1 L_th51
    s_waitcnt vmcnt(4)
L_th51:
    buffer_load_dwordx4 v[128:131], v2, s[44:47], s52 offen offset:0 nt
    s_waitcnt lgkmcnt(0)
    v_readfirstlane_b32 s57, v51
    v_add_u32 v48, 1, v48
    ds_write_b32 v49, v48
    ds_read_b32 v51, v50
    v_mfma_f32_16x16x32_bf16 v[16:19], v[100:103], v[36:39], v[16:19]
    s_waitcnt vmcnt(6)
    s_cmp_eq_u32 s57, 0
    s_cbranch_scc1 L_th52
    s_waitcnt vmcnt(5)
    s_cmp_lg_u32 s57, 2
    s_cbranch_scc1 L_th52
    s_waitcnt vmcnt(4)
L_th52:
    buffer_load_dwordx4 v[132:135], v2, s[44:47], s52 offen offset:1024 nt
    v_mfma_f32_16x16x32_bf16 v[16:19], v[104:107], v[40:43], v[16:19]
    s_waitcnt vmcnt(6)
    s_cmp_eq_u32 s57, 0
    s_cbranch_scc1 L_th53
    s_waitcnt vmcnt(5)
    s_cmp_lg_u32 s57, 2
    s_cbranch_scc1 L_th53
    s_waitcnt vmcnt(4)
L_th53:
    buffer_load_dwordx4 v[136:139], v2, s[44:47], s52 offen offset:2048 nt
    v_mfma_f32_16x16x32_bf16 v[16:19], v[108:111], v[44:47], v[16:19]
    s_waitcnt vmcnt(6)
    s_cmp_eq_u32 s57, 0
    s_cbranch_scc1 L_th54
    s_waitcnt vmcnt(5)
    s_cmp_lg_u32 s57, 2
    s_cbranch_scc1 L_th54
    s_waitcnt vmcnt(4)
L_th54:
    buffer_load_dwordx4 v[140:143], v2, s[44:47], s52 offen offset:3072 nt
    s_add_u32 s52, s52, 16384
    s_nop 7
    v_add_f32_dpp v11, v18, v16 row_ror:8 row_mask:0xf bank_mask:0xf
    v_add_f32_dpp v12, v19, v17 row_ror:8 row_mask:0xf bank_mask:0xf
    s_nop 1
    v_add_f32_dpp v10, v12, v11 row_ror:12 row_mask:0xf bank_mask:0x1
    v_mfma_f32_16x16x32_bf16 v[16:19], v[112:115], v[32:35], 0
    s_waitcnt vmcnt(6)
    s_cmp_eq_u32 s57, 0
    s_cbranch_scc1 L_th55
    s_waitcnt vmcnt(5)
    s_cmp_lg_u32 s57, 2
    s_cbranch_scc1 L_th55
    s_waitcnt vmcnt(4)
L_th55:
    buffer_load_dwordx4 v[144:147], v2, s[44:47], s52 offen offset:0 nt
    s_waitcnt lgkmcnt(0)
    v_readfirstlane_b32 s57, v51
    v_add_u32 v48, 1, v48
    ds_write_b32 v49, v48
    ds_read_b32 v51, v50
    v_mfma_f32_16x16x32_bf16 v[16:19], v[116:119], v[36:39], v[16:19]
    s_waitcnt vmcnt(6)
    s_cmp_eq_u32 s57, 0
    s_cbranch_scc1 L_th56
    s_waitcnt vmcnt(5)
    s_cmp_lg_u32 s57, 2
    s_cbranch_scc1 L_th56
    s_waitcnt vmcnt(4)
L_th56:
    buffer_load_dwordx4 v[148:151], v2, s[44:47], s52 offen offset:1024 nt
    v_mfma_f32_16x16x32_bf16 v[16:19], v[120:123], v[40:43], v[16:19]
    s_waitcnt vmcnt(6)
    s_cmp_eq_u32 s57, 0
    s_cbranch_scc1 L_th57
    s_waitcnt vmcnt(5)
    s_cmp_lg_u32 s57, 2
    s_cbranch_scc1 L_th57
    s_waitcnt vmcnt(4)
L_th57:
    buffer_load_dwordx4 v[152:155], v2, s[44:47], s52 offen offset:2048 nt
    v_mfma_f32_16x16x32_bf16 v[16:19], v[124:127], v[44:47], v[16:19]
    s_waitcnt vmcnt(6)
    s_cmp_eq_u32 s57, 0
    s_cbranch_scc1 L_th58
    s_waitcnt vmcnt(5)
    s_cmp_lg_u32 s57, 2
    s_cbranch_scc1 L_th58
    s_waitcnt vmcnt(4)
L_th58:
    buffer_load_dwordx4 v[156:159], v2, s[44:47], s52 offen offset:3072 nt
    s_add_u32 s52, s52, 16384
    s_nop 7
    v_add_f32_dpp v11, v19, v17 row_ror:8 row_mask:0xf bank_mask:0xf
    v_add_f32_dpp v12, v18, v16 row_ror:8 row_mask:0xf bank_mask:0xf
    s_nop 1
    v_add_f32_dpp v10, v12, v11 row_ror:4 row_mask:0xf bank_mask:0x2
    v_mfma_f32_16x16x32_bf16 v[16:19], v[128:131], v[32:35], 0
    s_waitcnt vmcnt(6)
    s_cmp_eq_u32 s57, 0
    s_cbranch_scc1 L_th59
    s_waitcnt vmcnt(5)
    s_cmp_lg_u32 s57, 2
    s_cbranch_scc1 L_th59
    s_waitcnt vmcnt(4)
L_th59:
    buffer_load_dwordx4 v[160:163], v2, s[44:47], s52 offen offset:0 nt
    s_waitcnt lgkmcnt(0)
    v_readfirstlane_b32 s57, v51
    v_add_u32 v48, 1, v48
    ds_write_b32 v49, v48
    ds_read_b32 v51, v50
    v_mfma_f32_16x16x32_bf16 v[16:19], v[132:135], v[36:39], v[16:19]
    s_waitcnt vmcnt(6)
    s_cmp_eq_u32 s57, 0
    s_cbranch_scc1 L_th60
    s_waitcnt vmcnt(5)
    s_cmp_lg_u32 s57, 2
    s_cbranch_scc1 L_th60
    s_waitcnt vmcnt(4)
L_th60:
    buffer_load_dwordx4 v[164:167], v2, s[44:47], s52 offen offset:1024 nt
    v_mfma_f32_16x16x32_bf16 v[16:19], v[136:139], v[40:43], v[16:19]
    s_waitcnt vmcnt(6)
    s_cmp_eq_u32 s57, 0
    s_cbranch_scc1 L_th61
    s_waitcnt vmcnt(5)
    s_cmp_lg_u32 s57, 2
    s_cbranch_scc1 L_th61
    s_waitcnt vmcnt(4)
L_th61:
    buffer_load_dwordx4 v[168:171], v2, s[44:47], s52 offen offset:2048 nt
    v_mfma_f32_16x16x32_bf16 v[16:19], v[140:143], v[44:47], v[16:19]
    s_waitcnt vmcnt(6)
    s_cmp_eq_u32 s57, 0
    s_cbranch_scc1 L_th62
    s_waitcnt vmcnt(5)
    s_cmp_lg_u32 s57, 2
    s_cbranch_scc1 L_th62
    s_waitcnt vmcnt(4)
L_th62:
    buffer_load_dwordx4 v[172:175], v2, s[44:47], s52 offen offset:3072 nt
    s_add_u32 s52, s52, 16384
    s_nop 7
    v_add_f32_dpp v11, v16, v18 row_ror:8 row_mask:0xf bank_mask:0xf
    v_add_f32_dpp v12, v17, v19 row_ror:8 row_mask:0xf bank_mask:0xf
    s_nop 1
    v_add_f32_dpp v10, v12, v11 row_ror:12 row_mask:0xf bank_mask:0x4
    v_mfma_f32_16x16x32_bf16 v[16:19], v[144:147], v[32:35], 0
    s_waitcnt vmcnt(6)
    s_cmp_eq_u32 s57, 0
    s_cbranch_scc1 L_th63
    s_waitcnt vmcnt(5)
    s_cmp_lg_u32 s57, 2
    s_cbranch_scc1 L_th63
    s_waitcnt vmcnt(4)
L_th63:
    buffer_load_dwordx4 v[176:179], v2, s[44:47], s52 offen offset:0 nt
    s_waitcnt lgkmcnt(0)
    v_readfirstlane_b32 s57, v51
    v_add_u32 v48, 1, v48
    ds_write_b32 v49, v48
    ds_read_b32 v51, v50
    v_mfma_f32_16x16x32_bf16 v[16:19], v[148:151], v[36:39], v[16:19]
    s_waitcnt vmcnt(6)
    s_cmp_eq_u32 s57, 0
    s_cbranch_scc1 L_th64
    s_waitcnt vmcnt(5)
    s_cmp_lg_u32 s57, 2
    s_cbranch_scc1 L_th64
    s_waitcnt vmcnt(4)
L_th64:
    buffer_load_dwordx4 v[180:183], v2, s[44:47], s52 offen offset:1024 nt
    v_mfma_f32_16x16x32_bf16 v[16:19], v[152:155], v[40:43], v[16:19]
    s_waitcnt vmcnt(6)
    s_cmp_eq_u32 s57, 0
    s_cbranch_scc1 L_th65
    s_waitcnt vmcnt(5)
    s_cmp_lg_u32 s57, 2
    s_cbranch_scc1 L_th65
    s_waitcnt vmcnt(4)
L_th65:
    buffer_load_dwordx4 v[184:187], v2, s[44:47], s52 offen offset:2048 nt
    v_mfma_f32_16x16x32_bf16 v[16:19], v[156:159], v[44:47], v[16:19]
    s_waitcnt vmcnt(6)
    s_cmp_eq_u32 s57, 0
    s_cbranch_scc1 L_th66
    s_waitcnt vmcnt(5)
    s_cmp_lg_u32 s57, 2
    s_cbranch_scc1 L_th66
    s_waitcnt vmcnt(4)
L_th66:
    buffer_load_dwordx4 v[188:191], v2, s[44:47], s52 offen offset:3072 nt
    s_add_u32 s52, s52, 16384
    s_nop 7
    v_add_f32_dpp v11, v17, v19 row_ror:8 row_mask:0xf bank_mask:0xf
    v_add_f32_dpp v12, v16, v18 row_ror:8 row_mask:0xf bank_mask:0xf
    s_nop 1
    v_add_f32_dpp v10, v12, v11 row_ror:4 row_mask:0xf bank_mask:0x8
    v_cvt_pk_bf16_f32 v13, v10, v10
    v_and_b32 v13, 0xffff0000, v13
    v_mul_f32 v13, 0x3db504f3, v13
    v_cvt_pk_bf16_f32 v13, v13, v13
    v_and_b32 v13, 0xffff0000, v13
    ds_write_b32 v28, v13 offset:0
    v_max_f32 v14, v8, v13
    v_sub_f32 v11, v8, v14
    v_sub_f32 v12, v13, v14
    v_mul_f32 v11, 0x3fb8aa3b, v11
    v_mul_f32 v12, 0x3fb8aa3b, v12
    v_exp_f32 v11, v11
    v_exp_f32 v12, v12
    v_mov_b32 v8, v14
    v_fma_f32 v9, v9, v11, v12
    v_mfma_f32_16x16x32_bf16 v[16:19], v[160:163], v[32:35], 0
    s_waitcnt vmcnt(6)
    s_cmp_eq_u32 s57, 0
    s_cbranch_scc1 L_th67
    s_waitcnt vmcnt(5)
    s_cmp_lg_u32 s57, 2
    s_cbranch_scc1 L_th67
    s_waitcnt vmcnt(4)
L_th67:
    buffer_load_dwordx4 v[64:67], v2, s[44:47], s52 offen offset:0 nt
    s_waitcnt lgkmcnt(0)
    v_readfirstlane_b32 s57, v51
    v_add_u32 v48, 1, v48
    ds_write_b32 v49, v48
    ds_read_b32 v51, v50
    v_mfma_f32_16x16x32_bf16 v[16:19], v[164:167], v[36:39], v[16:19]
    s_waitcnt vmcnt(6)
    s_cmp_eq_u32 s57, 0
    s_cbranch_scc1 L_th68
    s_waitcnt vmcnt(5)
    s_cmp_lg_u32 s57, 2
    s_cbranch_scc1 L_th68
    s_waitcnt vmcnt(4)
L_th68:
    buffer_load_dwordx4 v[68:71], v2, s[44:47], s52 offen offset:1024 nt
    v_mfma_f32_16x16x32_bf16 v[16:19], v[168:171], v[40:43], v[16:19]
    s_waitcnt vmcnt(6)
    s_cmp_eq_u32 s57, 0
    s_cbranch_scc1 L_th69
    s_waitcnt vmcnt(5)
    s_cmp_lg_u32 s57, 2
    s_cbranch_scc1 L_th69
    s_waitcnt vmcnt(4)
L_th69:
    buffer_load_dwordx4 v[72:75], v2, s[44:47], s52 offen offset:2048 nt
    v_mfma_f32_16x16x32_bf16 v[16:19], v[172:175], v[44:47], v[16:19]
    s_waitcnt vmcnt(6)
    s_cmp_eq_u32 s57, 0
    s_cbranch_scc1 L_th70
    s_waitcnt vmcnt(5)
    s_cmp_lg_u32 s57, 2
    s_cbranch_scc1 L_th70
    s_waitcnt vmcnt(4)
L_th70:
    buffer_load_dwordx4 v[76:79], v2, s[44:47], s52 offen offset:3072 nt
    s_add_u32 s52, s52, 16384
    s_nop 7
    v_add_f32_dpp v11, v18, v16 row_ror:8 row_mask:0xf bank_mask:0xf
    v_add_f32_dpp v12, v19, v17 row_ror:8 row_mask:0xf bank_mask:0xf
    s_nop 1
    v_add_f32_dpp v10, v12, v11 row_ror:12 row_mask:0xf bank_mask:0x1
    v_mfma_f32_16x16x32_bf16 v[16:19], v[176:179], v[32:35], 0
    s_waitcnt vmcnt(6)
    s_cmp_eq_u32 s57, 0
    s_cbranch_scc1 L_th71
    s_waitcnt vmcnt(5)
    s_cmp_lg_u32 s57, 2
    s_cbranch_scc1 L_th71
    s_waitcnt vmcnt(4)
L_th71:
    buffer_load_dwordx4 v[80:83], v2, s[44:47], s52 offen offset:0 nt
    s_waitcnt lgkmcnt(0)
    v_readfirstlane_b32 s57, v51
    v_add_u32 v48, 1, v48
    ds_write_b32 v49, v48
    ds_read_b32 v51, v50
    v_mfma_f32_16x16x32_bf16 v[16:19], v[180:183], v[36:39], v[16:19]
    s_waitcnt vmcnt(6)
    s_cmp_eq_u32 s57, 0
    s_cbranch_scc1 L_th72
    s_waitcnt vmcnt(5)
    s_cmp_lg_u32 s57, 2
    s_cbranch_scc1 L_th72
    s_waitcnt vmcnt(4)
L_th72:
    buffer_load_dwordx4 v[84:87], v2, s[44:47], s52 offen offset:1024 nt
    v_mfma_f32_16x16x32_bf16 v[16:19], v[184:187], v[40:43], v[16:19]
    s_waitcnt vmcnt(6)
    s_cmp_eq_u32 s57, 0
    s_cbranch_scc1 L_th73
    s_waitcnt vmcnt(5)
    s_cmp_lg_u32 s57, 2
    s_cbranch_scc1 L_th73
    s_waitcnt vmcnt(4)
L_th73:
    buffer_load_dwordx4 v[88:91], v2, s[44:47], s52 offen offset:2048 nt
    v_mfma_f32_16x16x32_bf16 v[16:19], v[188:191], v[44:47], v[16:19]
    s_waitcnt vmcnt(6)
    s_cmp_eq_u32 s57, 0
    s_cbranch_scc1 L_th74
    s_waitcnt vmcnt(5)
    s_cmp_lg_u32 s57, 2
    s_cbranch_scc1 L_th74
    s_waitcnt vmcnt(4)
L_th74:
    buffer_load_dwordx4 v[92:95], v2, s[44:47], s52 offen offset:3072 nt
    s_add_u32 s52, s52, 16384
    s_nop 7
    v_add_f32_dpp v11, v19, v17 row_ror:8 row_mask:0xf bank_mask:0xf
    v_add_f32_dpp v12, v18, v16 row_ror:8 row_mask:0xf bank_mask:0xf
    s_nop 1
    v_add_f32_dpp v10, v12, v11 row_ror:4 row_mask:0xf bank_mask:0x2
    v_mfma_f32_16x16x32_bf16 v[16:19], v[64:67], v[32:35], 0
    s_waitcnt vmcnt(6)
    s_cmp_eq_u32 s57, 0
    s_cbranch_scc1 L_th75
    s_waitcnt vmcnt(5)
    s_cmp_lg_u32 s57, 2
    s_cbranch_scc1 L_th75
    s_waitcnt vmcnt(4)
L_th75:
    buffer_load_dwordx4 v[96:99], v2, s[44:47], s52 offen offset:0 nt
    s_waitcnt lgkmcnt(0)
    v_readfirstlane_b32 s57, v51
    v_add_u32 v48, 1, v48
    ds_write_b32 v49, v48
    ds_read_b32 v51, v50
    v_mfma_f32_16x16x32_bf16 v[16:19], v[68:71], v[36:39], v[16:19]
    s_waitcnt vmcnt(6)
    s_cmp_eq_u32 s57, 0
    s_cbranch_scc1 L_th76
    s_waitcnt vmcnt(5)
    s_cmp_lg_u32 s57, 2
    s_cbranch_scc1 L_th76
    s_waitcnt vmcnt(4)
L_th76:
    buffer_load_dwordx4 v[100:103], v2, s[44:47], s52 offen offset:1024 nt
    v_mfma_f32_16x16x32_bf16 v[16:19], v[72:75], v[40:43], v[16:19]
    s_waitcnt vmcnt(6)
    s_cmp_eq_u32 s57, 0
    s_cbranch_scc1 L_th77
    s_waitcnt vmcnt(5)
    s_cmp_lg_u32 s57, 2
    s_cbranch_scc1 L_th77
    s_waitcnt vmcnt(4)
L_th77:
    buffer_load_dwordx4 v[104:107], v2, s[44:47], s52 offen offset:2048 nt
    v_mfma_f32_16x16x32_bf16 v[16:19], v[76:79], v[44:47], v[16:19]
    s_waitcnt vmcnt(6)
    s_cmp_eq_u32 s57, 0
    s_cbranch_scc1 L_th78
    s_waitcnt vmcnt(5)
    s_cmp_lg_u32 s57, 2
    s_cbranch_scc1 L_th78
    s_waitcnt vmcnt(4)
L_th78:
    buffer_load_dwordx4 v[108:111], v2, s[44:47], s52 offen offset:3072 nt
    s_add_u32 s52, s52, 16384
    s_nop 7
    v_add_f32_dpp v11, v16, v18 row_ror:8 row_mask:0xf bank_mask:0xf
    v_add_f32_dpp v12, v17, v19 row_ror:8 row_mask:0xf bank_mask:0xf
    s_nop 1
    v_add_f32_dpp v10, v12, v11 row_ror:12 row_mask:0xf bank_mask:0x4
    v_mfma_f32_16x16x32_bf16 v[16:19], v[80:83], v[32:35], 0
    s_waitcnt vmcnt(6)
    s_cmp_eq_u32 s57, 0
    s_cbranch_scc1 L_th79
    s_waitcnt vmcnt(5)
    s_cmp_lg_u32 s57, 2
    s_cbranch_scc1 L_th79
    s_waitcnt vmcnt(4)
L_th79:
    buffer_load_dwordx4 v[112:115], v2, s[44:47], s52 offen offset:0 nt
    s_waitcnt lgkmcnt(0)
    v_readfirstlane_b32 s57, v51
    v_add_u32 v48, 1, v48
    ds_write_b32 v49, v48
    ds_read_b32 v51, v50
    v_mfma_f32_16x16x32_bf16 v[16:19], v[84:87], v[36:39], v[16:19]
    s_waitcnt vmcnt(6)
    s_cmp_eq_u32 s57, 0
    s_cbranch_scc1 L_th80
    s_waitcnt vmcnt(5)
    s_cmp_lg_u32 s57, 2
    s_cbranch_scc1 L_th80
    s_waitcnt vmcnt(4)
L_th80:
    buffer_load_dwordx4 v[116:119], v2, s[44:47], s52 offen offset:1024 nt
    v_mfma_f32_16x16x32_bf16 v[16:19], v[88:91], v[40:43], v[16:19]
    s_waitcnt vmcnt(6)
    s_cmp_eq_u32 s57, 0
    s_cbranch_scc1 L_th81
    s_waitcnt vmcnt(5)
    s_cmp_lg_u32 s57, 2
    s_cbranch_scc1 L_th81
    s_waitcnt vmcnt(4)
L_th81:
    buffer_load_dwordx4 v[120:123], v2, s[44:47], s52 offen offset:2048 nt
    v_mfma_f32_16x16x32_bf16 v[16:19], v[92:95], v[44:47], v[16:19]
    s_waitcnt vmcnt(6)
    s_cmp_eq_u32 s57, 0
    s_cbranch_scc1 L_th82
    s_waitcnt vmcnt(5)
    s_cmp_lg_u32 s57, 2
    s_cbranch_scc1 L_th82
    s_waitcnt vmcnt(4)
L_th82:
    buffer_load_dwordx4 v[124:127], v2, s[44:47], s52 offen offset:3072 nt
    s_add_u32 s52, s52, 16384
    s_nop 7
    v_add_f32_dpp v11, v17, v19 row_ror:8 row_mask:0xf bank_mask:0xf
    v_add_f32_dpp v12, v16, v18 row_ror:8 row_mask:0xf bank_mask:0xf
    s_nop 1
    v_add_f32_dpp v10, v12, v11 row_ror:4 row_mask:0xf bank_mask:0x8
    v_cvt_pk_bf16_f32 v13, v10, v10
    v_and_b32 v13, 0xffff0000, v13
    v_mul_f32 v13, 0x3db504f3, v13
    v_cvt_pk_bf16_f32 v13, v13, v13
    v_and_b32 v13, 0xffff0000, v13
    ds_write_b32 v28, v13 offset:256
    v_max_f32 v14, v8, v13
    v_sub_f32 v11, v8, v14
    v_sub_f32 v12, v13, v14
    v_mul_f32 v11, 0x3fb8aa3b, v11
    v_mul_f32 v12, 0x3fb8aa3b, v12
    v_exp_f32 v11, v11
    v_exp_f32 v12, v12
    v_mov_b32 v8, v14
    v_fma_f32 v9, v9, v11, v12
    v_add_u32 v28, 512, v28
    s_sub_u32 s54, s54, 1
    s_cmp_lg_u32 s54, 0
    s_cbranch_scc1 L_kloop
    v_mfma_f32_16x16x32_bf16 v[16:19], v[96:99], v[32:35], 0
    s_waitcnt vmcnt(6)
    s_cmp_eq_u32 s57, 0
    s_cbranch_scc1 L_th83
    s_waitcnt vmcnt(5)
    s_cmp_lg_u32 s57, 2
    s_cbranch_scc1 L_th83
    s_waitcnt vmcnt(4)
L_th83:
    buffer_load_dwordx4 v[128:131], v2, s[44:47], s52 offen offset:0 nt
    s_waitcnt lgkmcnt(0)
    v_readfirstlane_b32 s57, v51
    v_add_u32 v48, 1, v48
    ds_write_b32 v49, v48
    ds_read_b32 v51, v50
    v_mfma_f32_16x16x32_bf16 v[16:19], v[100:103], v[36:39], v[16:19]
    s_waitcnt vmcnt(6)
    s_cmp_eq_u32 s57, 0
    s_cbranch_scc1 L_th84
    s_waitcnt vmcnt(5)
    s_cmp_lg_u32 s57, 2
    s_cbranch_scc1 L_th84
    s_waitcnt vmcnt(4)
L_th84:
    buffer_load_dwordx4 v[132:135], v2, s[44:47], s52 offen offset:1024 nt
    v_mfma_f32_16x16x32_bf16 v[16:19], v[104:107], v[40:43], v[16:19]
    s_waitcnt vmcnt(6)
    s_cmp_eq_u32 s57, 0
    s_cbranch_scc1 L_th85
    s_waitcnt vmcnt(5)
    s_cmp_lg_u32 s57, 2
    s_cbranch_scc1 L_th85
    s_waitcnt vmcnt(4)
L_th85:
    buffer_load_dwordx4 v[136:139], v2, s[44:47], s52 offen offset:2048 nt
    v_mfma_f32_16x16x32_bf16 v[16:19], v[108:111], v[44:47], v[16:19]
    s_waitcnt vmcnt(6)
    s_cmp_eq_u32 s57, 0
    s_cbranch_scc1 L_th86
    s_waitcnt vmcnt(5)
    s_cmp_lg_u32 s57, 2
    s_cbranch_scc1 L_th86
    s_waitcnt vmcnt(4)
L_th86:
    buffer_load_dwordx4 v[140:143], v2, s[44:47], s52 offen offset:3072 nt
    s_add_u32 s52, s52, 16384
    s_nop 7
    v_add_f32_dpp v11, v18, v16 row_ror:8 row_mask:0xf bank_mask:0xf
    v_add_f32_dpp v12, v19, v17 row_ror:8 row_mask:0xf bank_mask:0xf
    s_nop 1
    v_add_f32_dpp v10, v12, v11 row_ror:12 row_mask:0xf bank_mask:0x1
    v_mfma_f32_16x16x32_bf16 v[16:19], v[112:115], v[32:35], 0
    s_waitcnt vmcnt(6)
    s_cmp_eq_u32 s57, 0
    s_cbranch_scc1 L_th87
    s_waitcnt vmcnt(5)
    s_cmp_lg_u32 s57, 2
    s_cbranch_scc1 L_th87
    s_waitcnt vmcnt(4)
L_th87:
    buffer_load_dwordx4 v[144:147], v2, s[44:47], s52 offen offset:0 nt
    s_waitcnt lgkmcnt(0)
    v_readfirstlane_b32 s57, v51
    v_add_u32 v48, 1, v48
    ds_write_b32 v49, v48
    ds_read_b32 v51, v50
    v_mfma_f32_16x16x32_bf16 v[16:19], v[116:119], v[36:39], v[16:19]
    s_waitcnt vmcnt(6)
    s_cmp_eq_u32 s57, 0
    s_cbranch_scc1 L_th88
    s_waitcnt vmcnt(5)
    s_cmp_lg_u32 s57, 2
    s_cbranch_scc1 L_th88
    s_waitcnt vmcnt(4)
L_th88:
    buffer_load_dwordx4 v[148:151], v2, s[44:47], s52 offen offset:1024 nt
    v_mfma_f32_16x16x32_bf16 v[16:19], v[120:123], v[40:43], v[16:19]
    s_waitcnt vmcnt(6)
    s_cmp_eq_u32 s57, 0
    s_cbranch_scc1 L_th89
    s_waitcnt vmcnt(5)
    s_cmp_lg_u32 s57, 2
    s_cbranch_scc1 L_th89
    s_waitcnt vmcnt(4)
L_th89:
    buffer_load_dwordx4 v[152:155], v2, s[44:47], s52 offen offset:2048 nt
    v_mfma_f32_16x16x32_bf16 v[16:19], v[124:127], v[44:47], v[16:19]
    s_waitcnt vmcnt(6)
    s_cmp_eq_u32 s57, 0
    s_cbranch_scc1 L_th90
    s_waitcnt vmcnt(5)
    s_cmp_lg_u32 s57, 2
    s_cbranch_scc1 L_th90
    s_waitcnt vmcnt(4)
L_th90:
    buffer_load_dwordx4 v[156:159], v2, s[44:47], s52 offen offset:3072 nt
    s_add_u32 s52, s52, 16384
    s_nop 7
    v_add_f32_dpp v11, v19, v17 row_ror:8 row_mask:0xf bank_mask:0xf
    v_add_f32_dpp v12, v18, v16 row_ror:8 row_mask:0xf bank_mask:0xf
    s_nop 1
    v_add_f32_dpp v10, v12, v11 row_ror:4 row_mask:0xf bank_mask:0x2
    v_mfma_f32_16x16x32_bf16 v[16:19], v[128:131], v[32:35], 0
    s_waitcnt vmcnt(6)
    s_cmp_eq_u32 s57, 0
    s_cbranch_scc1 L_th91
    s_waitcnt vmcnt(5)
    s_cmp_lg_u32 s57, 2
    s_cbranch_scc1 L_th91
    s_waitcnt vmcnt(4)
L_th91:
    buffer_load_dwordx4 v[160:163], v2, s[44:47], s52 offen offset:0 nt
    s_waitcnt lgkmcnt(0)
    v_readfirstlane_b32 s57, v51
    v_add_u32 v48, 1, v48
    ds_write_b32 v49, v48
    ds_read_b32 v51, v50
    v_mfma_f32_16x16x32_bf16 v[16:19], v[132:135], v[36:39], v[16:19]
    s_waitcnt vmcnt(6)
    s_cmp_eq_u32 s57, 0
    s_cbranch_scc1 L_th92
    s_waitcnt vmcnt(5)
    s_cmp_lg_u32 s57, 2
    s_cbranch_scc1 L_th92
    s_waitcnt vmcnt(4)
L_th92:
    buffer_load_dwordx4 v[164:167], v2, s[44:47], s52 offen offset:1024 nt
    v_mfma_f32_16x16x32_bf16 v[16:19], v[136:139], v[40:43], v[16:19]
    s_waitcnt vmcnt(6)
    s_cmp_eq_u32 s57, 0
    s_cbranch_scc1 L_th93
    s_waitcnt vmcnt(5)
    s_cmp_lg_u32 s57, 2
    s_cbranch_scc1 L_th93
    s_waitcnt vmcnt(4)
L_th93:
    buffer_load_dwordx4 v[168:171], v2, s[44:47], s52 offen offset:2048 nt
    v_mfma_f32_16x16x32_bf16 v[16:19], v[140:143], v[44:47], v[16:19]
    s_waitcnt vmcnt(6)
    s_cmp_eq_u32 s57, 0
    s_cbranch_scc1 L_th94
    s_waitcnt vmcnt(5)
    s_cmp_lg_u32 s57, 2
    s_cbranch_scc1 L_th94
    s_waitcnt vmcnt(4)
L_th94:
    buffer_load_dwordx4 v[172:175], v2, s[44:47], s52 offen offset:3072 nt
    s_add_u32 s52, s52, 16384
    s_nop 7
    v_add_f32_dpp v11, v16, v18 row_ror:8 row_mask:0xf bank_mask:0xf
    v_add_f32_dpp v12, v17, v19 row_ror:8 row_mask:0xf bank_mask:0xf
    s_nop 1
    v_add_f32_dpp v10, v12, v11 row_ror:12 row_mask:0xf bank_mask:0x4
    v_mfma_f32_16x16x32_bf16 v[16:19], v[144:147], v[32:35], 0
    s_waitcnt vmcnt(6)
    s_cmp_eq_u32 s57, 0
    s_cbranch_scc1 L_th95
    s_waitcnt vmcnt(5)
    s_cmp_lg_u32 s57, 2
    s_cbranch_scc1 L_th95
    s_waitcnt vmcnt(4)
L_th95:
    buffer_load_dwordx4 v[176:179], v2, s[44:47], s52 offen offset:0 nt
    s_waitcnt lgkmcnt(0)
    v_readfirstlane_b32 s57, v51
    v_add_u32 v48, 1, v48
    ds_write_b32 v49, v48
    ds_read_b32 v51, v50
    v_mfma_f32_16x16x32_bf16 v[16:19], v[148:151], v[36:39], v[16:19]
    s_waitcnt vmcnt(6)
    s_cmp_eq_u32 s57, 0
    s_cbranch_scc1 L_th96
    s_waitcnt vmcnt(5)
    s_cmp_lg_u32 s57, 2
    s_cbranch_scc1 L_th96
    s_waitcnt vmcnt(4)
L_th96:
    buffer_load_dwordx4 v[180:183], v2, s[44:47], s52 offen offset:1024 nt
    v_mfma_f32_16x16x32_bf16 v[16:19], v[152:155], v[40:43], v[16:19]
    s_waitcnt vmcnt(6)
    s_cmp_eq_u32 s57, 0
    s_cbranch_scc1 L_th97
    s_waitcnt vmcnt(5)
    s_cmp_lg_u32 s57, 2
    s_cbranch_scc1 L_th97
    s_waitcnt vmcnt(4)
L_th97:
    buffer_load_dwordx4 v[184:187], v2, s[44:47], s52 offen offset:2048 nt
    v_mfma_f32_16x16x32_bf16 v[16:19], v[156:159], v[44:47], v[16:19]
    s_waitcnt vmcnt(6)
    s_cmp_eq_u32 s57, 0
    s_cbranch_scc1 L_th98
    s_waitcnt vmcnt(5)
    s_cmp_lg_u32 s57, 2
    s_cbranch_scc1 L_th98
    s_waitcnt vmcnt(4)
L_th98:
    buffer_load_dwordx4 v[188:191], v2, s[44:47], s52 offen offset:3072 nt
    s_add_u32 s52, s52, 16384
    s_nop 7
    v_add_f32_dpp v11, v17, v19 row_ror:8 row_mask:0xf bank_mask:0xf
    v_add_f32_dpp v12, v16, v18 row_ror:8 row_mask:0xf bank_mask:0xf
    s_nop 1
    v_add_f32_dpp v10, v12, v11 row_ror:4 row_mask:0xf bank_mask:0x8
    v_cvt_pk_bf16_f32 v13, v10, v10
    v_and_b32 v13, 0xffff0000, v13
    v_mul_f32 v13, 0x3db504f3, v13
    v_cvt_pk_bf16_f32 v13, v13, v13
    v_and_b32 v13, 0xffff0000, v13
    ds_write_b32 v28, v13 offset:0
    v_max_f32 v14, v8, v13
    v_sub_f32 v11, v8, v14
    v_sub_f32 v12, v13, v14
    v_mul_f32 v11, 0x3fb8aa3b, v11
    v_mul_f32 v12, 0x3fb8aa3b, v12
    v_exp_f32 v11, v11
    v_exp_f32 v12, v12
    v_mov_b32 v8, v14
    v_fma_f32 v9, v9, v11, v12
    v_mfma_f32_16x16x32_bf16 v[16:19], v[160:163], v[32:35], 0
    s_waitcnt vmcnt(6)
    s_cmp_eq_u32 s57, 0
    s_cbranch_scc1 L_th99
    s_waitcnt vmcnt(5)
    s_cmp_lg_u32 s57, 2
    s_cbranch_scc1 L_th99
    s_waitcnt vmcnt(4)
L_th99:
    buffer_load_dwordx4 v[64:67], v2, s[44:47], s52 offen offset:0 nt
    s_waitcnt lgkmcnt(0)
    v_readfirstlane_b32 s57, v51
    v_add_u32 v48, 1, v48
    ds_write_b32 v49, v48
    ds_read_b32 v51, v50
    v_mfma_f32_16x16x32_bf16 v[16:19], v[164:167], v[36:39], v[16:19]
    s_waitcnt vmcnt(6)
    s_cmp_eq_u32 s57, 0
    s_cbranch_scc1 L_th100
    s_waitcnt vmcnt(5)
    s_cmp_lg_u32 s57, 2
    s_cbranch_scc1 L_th100
    s_waitcnt vmcnt(4)
L_th100:
    buffer_load_dwordx4 v[68:71], v2, s[44:47], s52 offen offset:1024 nt
    v_mfma_f32_16x16x32_bf16 v[16:19], v[168:171], v[40:43], v[16:19]
    s_waitcnt vmcnt(6)
    s_cmp_eq_u32 s57, 0
    s_cbranch_scc1 L_th101
    s_waitcnt vmcnt(5)
    s_cmp_lg_u32 s57, 2
    s_cbranch_scc1 L_th101
    s_waitcnt vmcnt(4)
L_th101:
    buffer_load_dwordx4 v[72:75], v2, s[44:47], s52 offen offset:2048 nt
    v_mfma_f32_16x16x32_bf16 v[16:19], v[172:175], v[44:47], v[16:19]
    s_waitcnt vmcnt(6)
    s_cmp_eq_u32 s57, 0
    s_cbranch_scc1 L_th102
    s_waitcnt vmcnt(5)
    s_cmp_lg_u32 s57, 2
    s_cbranch_scc1 L_th102
    s_waitcnt vmcnt(4)
L_th102:
    buffer_load_dwordx4 v[76:79], v2, s[44:47], s52 offen offset:3072 nt
    s_add_u32 s52, s52, 16384
    s_nop 7
    v_add_f32_dpp v11, v18, v16 row_ror:8 row_mask:0xf bank_mask:0xf
    v_add_f32_dpp v12, v19, v17 row_ror:8 row_mask:0xf bank_mask:0xf
    s_nop 1
    v_add_f32_dpp v10, v12, v11 row_ror:12 row_mask:0xf bank_mask:0x1
    v_mfma_f32_16x16x32_bf16 v[16:19], v[176:179], v[32:35], 0
    s_waitcnt vmcnt(6)
    s_cmp_eq_u32 s57, 0
    s_cbranch_scc1 L_th103
    s_waitcnt vmcnt(5)
    s_cmp_lg_u32 s57, 2
    s_cbranch_scc1 L_th103
    s_waitcnt vmcnt(4)
L_th103:
    buffer_load_dwordx4 v[80:83], v2, s[44:47], s52 offen offset:0 nt
    s_waitcnt lgkmcnt(0)
    v_readfirstlane_b32 s57, v51
    v_add_u32 v48, 1, v48
    ds_write_b32 v49, v48
    ds_read_b32 v51, v50
    v_mfma_f32_16x16x32_bf16 v[16:19], v[180:183], v[36:39], v[16:19]
    s_waitcnt vmcnt(6)
    s_cmp_eq_u32 s57, 0
    s_cbranch_scc1 L_th104
    s_waitcnt vmcnt(5)
    s_cmp_lg_u32 s57, 2
    s_cbranch_scc1 L_th104
    s_waitcnt vmcnt(4)
L_th104:
    buffer_load_dwordx4 v[84:87], v2, s[44:47], s52 offen offset:1024 nt
    v_mfma_f32_16x16x32_bf16 v[16:19], v[184:187], v[40:43], v[16:19]
    s_waitcnt vmcnt(6)
    s_cmp_eq_u32 s57, 0
    s_cbranch_scc1 L_th105
    s_waitcnt vmcnt(5)
    s_cmp_lg_u32 s57, 2
    s_cbranch_scc1 L_th105
    s_waitcnt vmcnt(4)
L_th105:
    buffer_load_dwordx4 v[88:91], v2, s[44:47], s52 offen offset:2048 nt
    v_mfma_f32_16x16x32_bf16 v[16:19], v[188:191], v[44:47], v[16:19]
    s_waitcnt vmcnt(6)
    s_cmp_eq_u32 s57, 0
    s_cbranch_scc1 L_th106
    s_waitcnt vmcnt(5)
    s_cmp_lg_u32 s57, 2
    s_cbranch_scc1 L_th106
    s_waitcnt vmcnt(4)
L_th106:
    buffer_load_dwordx4 v[92:95], v2, s[44:47], s52 offen offset:3072 nt
    s_add_u32 s52, s52, 16384
    s_nop 7
    v_add_f32_dpp v11, v19, v17 row_ror:8 row_mask:0xf bank_mask:0xf
    v_add_f32_dpp v12, v18, v16 row_ror:8 row_mask:0xf bank_mask:0xf
    s_nop 1
    v_add_f32_dpp v10, v12, v11 row_ror:4 row_mask:0xf bank_mask:0x2
    v_mfma_f32_16x16x32_bf16 v[16:19], v[64:67], v[32:35], 0
    s_waitcnt vmcnt(6)
    s_cmp_eq_u32 s57, 0
    s_cbranch_scc1 L_th107
    s_waitcnt vmcnt(5)
    s_cmp_lg_u32 s57, 2
    s_cbranch_scc1 L_th107
    s_waitcnt vmcnt(4)
L_th107:
    buffer_load_dwordx4 v[96:99], v3, s[48:51], s53 offen offset:0 nt
    s_waitcnt lgkmcnt(0)
    v_readfirstlane_b32 s57, v51
    v_add_u32 v48, 1, v48
    ds_write_b32 v49, v48
    ds_read_b32 v51, v50
    v_mfma_f32_16x16x32_bf16 v[16:19], v[68:71], v[36:39], v[16:19]
    s_waitcnt vmcnt(6)
    s_cmp_eq_u32 s57, 0
    s_cbranch_scc1 L_th108
    s_waitcnt vmcnt(5)
    s_cmp_lg_u32 s57, 2
    s_cbranch_scc1 L_th108
    s_waitcnt vmcnt(4)
L_th108:
    buffer_load_dwordx4 v[100:103], v3, s[48:51], s53 offen offset:1024 nt
    v_mfma_f32_16x16x32_bf16 v[16:19], v[72:75], v[40:43], v[16:19]
    s_waitcnt vmcnt(6)
    s_cmp_eq_u32 s57, 0
    s_cbranch_scc1 L_th109
    s_waitcnt vmcnt(5)
    s_cmp_lg_u32 s57, 2
    s_cbranch_scc1 L_th109
    s_waitcnt vmcnt(4)
L_th109:
    buffer_load_dwordx4 v[104:107], v3, s[48:51], s53 offen offset:2048 nt
    v_mfma_f32_16x16x32_bf16 v[16:19], v[76:79], v[44:47], v[16:19]
    s_waitcnt vmcnt(6)
    s_cmp_eq_u32 s57, 0
    s_cbranch_scc1 L_th110
    s_waitcnt vmcnt(5)
    s_cmp_lg_u32 s57, 2
    s_cbranch_scc1 L_th110
    s_waitcnt vmcnt(4)
L_th110:
    buffer_load_dwordx4 v[108:111], v3, s[48:51], s53 offen offset:3072 nt
    s_add_u32 s53, s53, 16384
    s_nop 7
    v_add_f32_dpp v11, v16, v18 row_ror:8 row_mask:0xf bank_mask:0xf
    v_add_f32_dpp v12, v17, v19 row_ror:8 row_mask:0xf bank_mask:0xf
    s_nop 1
    v_add_f32_dpp v10, v12, v11 row_ror:12 row_mask:0xf bank_mask:0x4
    v_mfma_f32_16x16x32_bf16 v[16:19], v[80:83], v[32:35], 0
    s_waitcnt vmcnt(6)
    s_cmp_eq_u32 s57, 0
    s_cbranch_scc1 L_th111
    s_waitcnt vmcnt(5)
    s_cmp_lg_u32 s57, 2
    s_cbranch_scc1 L_th111
    s_waitcnt vmcnt(4)
L_th111:
    buffer_load_dwordx4 v[112:115], v3, s[48:51], s53 offen offset:0 nt
    s_waitcnt lgkmcnt(0)
    v_readfirstlane_b32 s57, v51
    v_add_u32 v48, 1, v48
    ds_write_b32 v49, v48
    ds_read_b32 v51, v50
    v_mfma_f32_16x16x32_bf16 v[16:19], v[84:87], v[36:39], v[16:19]
    s_waitcnt vmcnt(6)
    s_cmp_eq_u32 s57, 0
    s_cbranch_scc1 L_th112
    s_waitcnt vmcnt(5)
    s_cmp_lg_u32 s57, 2
    s_cbranch_scc1 L_th112
    s_waitcnt vmcnt(4)
L_th112:
    buffer_load_dwordx4 v[116:119], v3, s[48:51], s53 offen offset:1024 nt
    v_mfma_f32_16x16x32_bf16 v[16:19], v[88:91], v[40:43], v[16:19]
    s_waitcnt vmcnt(6)
    s_cmp_eq_u32 s57, 0
    s_cbranch_scc1 L_th113
    s_waitcnt vmcnt(5)
    s_cmp_lg_u32 s57, 2
    s_cbranch_scc1 L_th113
    s_waitcnt vmcnt(4)
L_th113:
    buffer_load_dwordx4 v[120:123], v3, s[48:51], s53 offen offset:2048 nt
    v_mfma_f32_16x16x32_bf16 v[16:19], v[92:95], v[44:47], v[16:19]
    s_waitcnt vmcnt(6)
    s_cmp_eq_u32 s57, 0
    s_cbranch_scc1 L_th114
    s_waitcnt vmcnt(5)
    s_cmp_lg_u32 s57, 2
    s_cbranch_scc1 L_th114
    s_waitcnt vmcnt(4)
L_th114:
    buffer_load_dwordx4 v[124:127], v3, s[48:51], s53 offen offset:3072 nt
    s_add_u32 s53, s53, 16384
    s_nop 7
    v_add_f32_dpp v11, v17, v19 row_ror:8 row_mask:0xf bank_mask:0xf
    v_add_f32_dpp v12, v16, v18 row_ror:8 row_mask:0xf bank_mask:0xf
    s_nop 1
    v_add_f32_dpp v10, v12, v11 row_ror:4 row_mask:0xf bank_mask:0x8
    v_cvt_pk_bf16_f32 v13, v10, v10
    v_and_b32 v13, 0xffff0000, v13
    v_mul_f32 v13, 0x3db504f3, v13
    v_cvt_pk_bf16_f32 v13, v13, v13
    v_and_b32 v13, 0xffff0000, v13
    ds_write_b32 v28, v13 offset:256
    v_max_f32 v14, v8, v13
    v_sub_f32 v11, v8, v14
    v_sub_f32 v12, v13, v14
    v_mul_f32 v11, 0x3fb8aa3b, v11
    v_mul_f32 v12, 0x3fb8aa3b, v12
    v_exp_f32 v11, v11
    v_exp_f32 v12, v12
    v_mov_b32 v8, v14
    v_fma_f32 v9, v9, v11, v12
    buffer_load_dwordx4 v[128:131], v3, s[48:51], s53 offen offset:0 nt
    s_waitcnt lgkmcnt(0)
    v_readfirstlane_b32 s57, v51
    v_add_u32 v48, 1, v48
    ds_write_b32 v49, v48
    ds_read_b32 v51, v50
    v_subrev_u32 v28, 7680, v28
    v_mov_b32 v11, v8
    s_nop 1
    v_max_f32_dpp v11, v11, v11 row_ror:8 row_mask:0xf bank_mask:0xf
    s_nop 1
    v_max_f32_dpp v11, v11, v11 row_ror:4 row_mask:0xf bank_mask:0xf
    s_nop 1
    v_max_f32_dpp v11, v11, v11 row_ror:2 row_mask:0xf bank_mask:0xf
    s_nop 1
    v_max_f32_dpp v11, v11, v11 row_ror:1 row_mask:0xf bank_mask:0xf
    s_nop 0
    v_readlane_b32 s60, v11, 0
    v_readlane_b32 s61, v11, 16
    v_readlane_b32 s62, v11, 32
    v_readlane_b32 s63, v11, 48
    s_nop 0
    v_mov_b32 v13, s60
    v_max_f32 v13, s61, v13
    v_max_f32 v13, s62, v13
    v_max_f32 v13, s63, v13
    v_sub_f32 v11, v8, v13
    v_mul_f32 v11, 0x3fb8aa3b, v11
    v_exp_f32 v11, v11
    s_nop 0
    v_mul_f32 v11, v9, v11
    buffer_load_dwordx4 v[132:135], v3, s[48:51], s53 offen offset:1024 nt
    s_nop 1
    v_add_f32_dpp v11, v11, v11 row_ror:8 row_mask:0xf bank_mask:0xf
    s_nop 1
    v_add_f32_dpp v11, v11, v11 row_ror:4 row_mask:0xf bank_mask:0xf
    s_nop 1
    v_add_f32_dpp v11, v11, v11 row_ror:2 row_mask:0xf bank_mask:0xf
    s_nop 1
    v_add_f32_dpp v11, v11, v11 row_ror:1 row_mask:0xf bank_mask:0xf
    s_nop 0
    v_readlane_b32 s60, v11, 0
    v_readlane_b32 s61, v11, 16
    v_readlane_b32 s62, v11, 32
    v_readlane_b32 s63, v11, 48
    s_nop 0
    v_mov_b32 v14, s60
    v_add_f32 v14, s61, v14
    v_add_f32 v14, s62, v14
    v_add_f32 v14, s63, v14
    v_mov_b32 v16, v13
    v_mov_b32 v17, v14
    s_lshl_b32 s55, s3, 3
    v_mov_b32 v11, s55
    v_mov_b32 v12, 0
    s_mov_b64 exec, 1
    ds_write_b64 v11, v[16:17] offset:2048
    s_mov_b64 exec, -1
    ds_read2st64_b32 v[26:27], v28 offset0:0 offset1:1
    buffer_load_dwordx4 v[136:139], v3, s[48:51], s53 offen offset:2048 nt
    buffer_load_dwordx4 v[140:143], v3, s[48:51], s53 offen offset:3072 nt
    s_add_u32 s53, s53, 16384
    s_waitcnt lgkmcnt(0)
    s_barrier
    ds_read_b128 v[192:195], v12 offset:2048
    ds_read_b128 v[196:199], v12 offset:2064
    s_waitcnt lgkmcnt(0)
    v_max3_f32 v29, v192, v194, v196
    v_max_f32 v29, v29, v198
    v_sub_f32 v192, v192, v29
    v_mul_f32 v192, 0x3fb8aa3b, v192
    v_exp_f32 v192, v192
    v_sub_f32 v194, v194, v29
    v_mul_f32 v194, 0x3fb8aa3b, v194
    v_exp_f32 v194, v194
    v_sub_f32 v196, v196, v29
    v_mul_f32 v196, 0x3fb8aa3b, v196
    v_exp_f32 v196, v196
    v_sub_f32 v198, v198, v29
    v_mul_f32 v198, 0x3fb8aa3b, v198
    v_exp_f32 v198, v198
    s_nop 0
    v_mul_f32 v11, v192, v193
    v_fma_f32 v11, v194, v195, v11
    v_fma_f32 v11, v196, v197, v11
    v_fma_f32 v11, v198, v199, v11
    v_rcp_f32 v30, v11
    s_nop 0
    v_fma_f32 v12, -v11, v30, 1.0
    v_fma_f32 v30, v12, v30, v30
    s_waitcnt lgkmcnt(0)
    v_sub_f32 v24, v26, v29
    v_sub_f32 v25, v27, v29
    v_mul_f32 v24, 0x3fb8aa3b, v24
    v_mul_f32 v25, 0x3fb8aa3b, v25
    v_exp_f32 v24, v24
    v_exp_f32 v25, v25
    v_add_u32 v28, 512, v28
    v_mul_f32 v24, v24, v30
    v_mul_f32 v25, v25, v30
    v_cvt_pk_bf16_f32 v24, v24, v24
    v_cvt_pk_bf16_f32 v25, v25, v25
    ds_read2st64_b32 v[26:27], v28 offset0:0 offset1:1
    s_nop 0
    v_and_b32_dpp v32, v24, v4 row_newbcast:0 row_mask:0xf bank_mask:0xf
    v_and_b32_dpp v33, v24, v5 row_newbcast:0 row_mask:0xf bank_mask:0xf
    v_and_b32_dpp v34, v24, v6 row_newbcast:0 row_mask:0xf bank_mask:0xf
    v_and_b32_dpp v35, v24, v7 row_newbcast:0 row_mask:0xf bank_mask:0xf
    v_and_b32_dpp v36, v24, v4 row_newbcast:1 row_mask:0xf bank_mask:0xf
    v_and_b32_dpp v37, v24, v5 row_newbcast:1 row_mask:0xf bank_mask:0xf
    v_and_b32_dpp v38, v24, v6 row_newbcast:1 row_mask:0xf bank_mask:0xf
    v_and_b32_dpp v39, v24, v7 row_newbcast:1 row_mask:0xf bank_mask:0xf
    v_and_b32_dpp v40, v24, v4 row_newbcast:2 row_mask:0xf bank_mask:0xf
    v_and_b32_dpp v41, v24, v5 row_newbcast:2 row_mask:0xf bank_mask:0xf
    v_and_b32_dpp v42, v24, v6 row_newbcast:2 row_mask:0xf bank_mask:0xf
    v_and_b32_dpp v43, v24, v7 row_newbcast:2 row_mask:0xf bank_mask:0xf
    v_and_b32_dpp v44, v24, v4 row_newbcast:3 row_mask:0xf bank_mask:0xf
    v_and_b32_dpp v45, v24, v5 row_newbcast:3 row_mask:0xf bank_mask:0xf
    v_and_b32_dpp v46, v24, v6 row_newbcast:3 row_mask:0xf bank_mask:0xf
    v_and_b32_dpp v47, v24, v7 row_newbcast:3 row_mask:0xf bank_mask:0xf
    v_mfma_f32_16x16x32_bf16 v[20:23], v[32:35], v[96:99], v[20:23]
    s_waitcnt vmcnt(6)
    s_cmp_eq_u32 s57, 0
    s_cbranch_scc1 L_th115
    s_waitcnt vmcnt(5)
    s_cmp_lg_u32 s57, 2
    s_cbranch_scc1 L_th115
    s_waitcnt vmcnt(4)
L_th115:
    buffer_load_dwordx4 v[144:147], v3, s[48:51], s53 offen offset:0 nt
    s_waitcnt lgkmcnt(0)
    v_readfirstlane_b32 s57, v51
    v_add_u32 v48, 1, v48
    ds_write_b32 v49, v48
    ds_read_b32 v51, v50
    v_mfma_f32_16x16x32_bf16 v[20:23], v[36:39], v[100:103], v[20:23]
    s_waitcnt vmcnt(6)
    s_cmp_eq_u32 s57, 0
    s_cbranch_scc1 L_th116
    s_waitcnt vmcnt(5)
    s_cmp_lg_u32 s57, 2
    s_cbranch_scc1 L_th116
    s_waitcnt vmcnt(4)
L_th116:
    buffer_load_dwordx4 v[148:151], v3, s[48:51], s53 offen offset:1024 nt
    v_mfma_f32_16x16x32_bf16 v[20:23], v[40:43], v[104:107], v[20:23]
    s_waitcnt vmcnt(6)
    s_cmp_eq_u32 s57, 0
    s_cbranch_scc1 L_th117
    s_waitcnt vmcnt(5)
    s_cmp_lg_u32 s57, 2
    s_cbranch_scc1 L_th117
    s_waitcnt vmcnt(4)
L_th117:
    buffer_load_dwordx4 v[152:155], v3, s[48:51], s53 offen offset:2048 nt
    v_mfma_f32_16x16x32_bf16 v[20:23], v[44:47], v[108:111], v[20:23]
    s_waitcnt vmcnt(6)
    s_cmp_eq_u32 s57, 0
    s_cbranch_scc1 L_th118
    s_waitcnt vmcnt(5)
    s_cmp_lg_u32 s57, 2
    s_cbranch_scc1 L_th118
    s_waitcnt vmcnt(4)
L_th118:
    buffer_load_dwordx4 v[156:159], v3, s[48:51], s53 offen offset:3072 nt
    s_add_u32 s53, s53, 16384
    v_and_b32_dpp v32, v24, v4 row_newbcast:4 row_mask:0xf bank_mask:0xf
    v_and_b32_dpp v33, v24, v5 row_newbcast:4 row_mask:0xf bank_mask:0xf
    v_and_b32_dpp v34, v24, v6 row_newbcast:4 row_mask:0xf bank_mask:0xf
    v_and_b32_dpp v35, v24, v7 row_newbcast:4 row_mask:0xf bank_mask:0xf
    v_and_b32_dpp v36, v24, v4 row_newbcast:5 row_mask:0xf bank_mask:0xf
    v_and_b32_dpp v37, v24, v5 row_newbcast:5 row_mask:0xf bank_mask:0xf
    v_and_b32_dpp v38, v24, v6 row_newbcast:5 row_mask:0xf bank_mask:0xf
    v_and_b32_dpp v39, v24, v7 row_newbcast:5 row_mask:0xf bank_mask:0xf
    v_and_b32_dpp v40, v24, v4 row_newbcast:6 row_mask:0xf bank_mask:0xf
    v_and_b32_dpp v41, v24, v5 row_newbcast:6 row_mask:0xf bank_mask:0xf
    v_and_b32_dpp v42, v24, v6 row_newbcast:6 row_mask:0xf bank_mask:0xf
    v_and_b32_dpp v43, v24, v7 row_newbcast:6 row_mask:0xf bank_mask:0xf
    v_and_b32_dpp v44, v24, v4 row_newbcast:7 row_mask:0xf bank_mask:0xf
    v_and_b32_dpp v45, v24, v5 row_newbcast:7 row_mask:0xf bank_mask:0xf
    v_and_b32_dpp v46, v24, v6 row_newbcast:7 row_mask:0xf bank_mask:0xf
    v_and_b32_dpp v47, v24, v7 row_newbcast:7 row_mask:0xf bank_mask:0xf
    v_mfma_f32_16x16x32_bf16 v[20:23], v[32:35], v[112:115], v[20:23]
    s_waitcnt vmcnt(6)
    s_cmp_eq_u32 s57, 0
    s_cbranch_scc1 L_th119
    s_waitcnt vmcnt(5)
    s_cmp_lg_u32 s57, 2
    s_cbranch_scc1 L_th119
    s_waitcnt vmcnt(4)
L_th119:
    buffer_load_dwordx4 v[160:163], v3, s[48:51], s53 offen offset:0 nt
    s_waitcnt lgkmcnt(0)
    v_readfirstlane_b32 s57, v51
    v_add_u32 v48, 1, v48
    ds_write_b32 v49, v48
    ds_read_b32 v51, v50
    v_mfma_f32_16x16x32_bf16 v[20:23], v[36:39], v[116:119], v[20:23]
    s_waitcnt vmcnt(6)
    s_cmp_eq_u32 s57, 0
    s_cbranch_scc1 L_th120
    s_waitcnt vmcnt(5)
    s_cmp_lg_u32 s57, 2
    s_cbranch_scc1 L_th120
    s_waitcnt vmcnt(4)
L_th120:
    buffer_load_dwordx4 v[164:167], v3, s[48:51], s53 offen offset:1024 nt
    v_mfma_f32_16x16x32_bf16 v[20:23], v[40:43], v[120:123], v[20:23]
    s_waitcnt vmcnt(6)
    s_cmp_eq_u32 s57, 0
    s_cbranch_scc1 L_th121
    s_waitcnt vmcnt(5)
    s_cmp_lg_u32 s57, 2
    s_cbranch_scc1 L_th121
    s_waitcnt vmcnt(4)
L_th121:
    buffer_load_dwordx4 v[168:171], v3, s[48:51], s53 offen offset:2048 nt
    v_mfma_f32_16x16x32_bf16 v[20:23], v[44:47], v[124:127], v[20:23]
    s_waitcnt vmcnt(6)
    s_cmp_eq_u32 s57, 0
    s_cbranch_scc1 L_th122
    s_waitcnt vmcnt(5)
    s_cmp_lg_u32 s57, 2
    s_cbranch_scc1 L_th122
    s_waitcnt vmcnt(4)
L_th122:
    buffer_load_dwordx4 v[172:175], v3, s[48:51], s53 offen offset:3072 nt
    s_add_u32 s53, s53, 16384
    v_and_b32_dpp v32, v24, v4 row_newbcast:8 row_mask:0xf bank_mask:0xf
    v_and_b32_dpp v33, v24, v5 row_newbcast:8 row_mask:0xf bank_mask:0xf
    v_and_b32_dpp v34, v24, v6 row_newbcast:8 row_mask:0xf bank_mask:0xf
    v_and_b32_dpp v35, v24, v7 row_newbcast:8 row_mask:0xf bank_mask:0xf
    v_and_b32_dpp v36, v24, v4 row_newbcast:9 row_mask:0xf bank_mask:0xf
    v_and_b32_dpp v37, v24, v5 row_newbcast:9 row_mask:0xf bank_mask:0xf
    v_and_b32_dpp v38, v24, v6 row_newbcast:9 row_mask:0xf bank_mask:0xf
    v_and_b32_dpp v39, v24, v7 row_newbcast:9 row_mask:0xf bank_mask:0xf
    v_and_b32_dpp v40, v24, v4 row_newbcast:10 row_mask:0xf bank_mask:0xf
    v_and_b32_dpp v41, v24, v5 row_newbcast:10 row_mask:0xf bank_mask:0xf
    v_and_b32_dpp v42, v24, v6 row_newbcast:10 row_mask:0xf bank_mask:0xf
    v_and_b32_dpp v43, v24, v7 row_newbcast:10 row_mask:0xf bank_mask:0xf
    v_and_b32_dpp v44, v24, v4 row_newbcast:11 row_mask:0xf bank_mask:0xf
    v_and_b32_dpp v45, v24, v5 row_newbcast:11 row_mask:0xf bank_mask:0xf
    v_and_b32_dpp v46, v24, v6 row_newbcast:11 row_mask:0xf bank_mask:0xf
    v_and_b32_dpp v47, v24, v7 row_newbcast:11 row_mask:0xf bank_mask:0xf
    v_mfma_f32_16x16x32_bf16 v[20:23], v[32:35], v[128:131], v[20:23]
    v_mfma_f32_16x16x32_bf16 v[20:23], v[36:39], v[132:135], v[20:23]
    s_waitcnt vmcnt(6)
    s_cmp_eq_u32 s57, 0
    s_cbranch_scc1 L_th123
    s_waitcnt vmcnt(5)
    s_cmp_lg_u32 s57, 2
    s_cbranch_scc1 L_th123
    s_waitcnt vmcnt(4)
L_th123:
    buffer_load_dwordx4 v[176:179], v3, s[48:51], s53 offen offset:0 nt
    s_waitcnt lgkmcnt(0)
    v_readfirstlane_b32 s57, v51
    v_add_u32 v48, 1, v48
    ds_write_b32 v49, v48
    ds_read_b32 v51, v50
    v_mfma_f32_16x16x32_bf16 v[20:23], v[40:43], v[136:139], v[20:23]
    s_waitcnt vmcnt(6)
    s_cmp_eq_u32 s57, 0
    s_cbranch_scc1 L_th124
    s_waitcnt vmcnt(5)
    s_cmp_lg_u32 s57, 2
    s_cbranch_scc1 L_th124
    s_waitcnt vmcnt(4)
L_th124:
    buffer_load_dwordx4 v[180:183], v3, s[48:51], s53 offen offset:1024 nt
    v_mfma_f32_16x16x32_bf16 v[20:23], v[44:47], v[140:143], v[20:23]
    s_waitcnt vmcnt(6)
    s_cmp_eq_u32 s57, 0
    s_cbranch_scc1 L_th125
    s_waitcnt vmcnt(5)
    s_cmp_lg_u32 s57, 2
    s_cbranch_scc1 L_th125
    s_waitcnt vmcnt(4)
L_th125:
    buffer_load_dwordx4 v[184:187], v3, s[48:51], s53 offen offset:2048 nt
    v_and_b32_dpp v32, v24, v4 row_newbcast:12 row_mask:0xf bank_mask:0xf
    v_and_b32_dpp v33, v24, v5 row_newbcast:12 row_mask:0xf bank_mask:0xf
    v_and_b32_dpp v34, v24, v6 row_newbcast:12 row_mask:0xf bank_mask:0xf
    v_and_b32_dpp v35, v24, v7 row_newbcast:12 row_mask:0xf bank_mask:0xf
    v_and_b32_dpp v36, v24, v4 row_newbcast:13 row_mask:0xf bank_mask:0xf
    v_and_b32_dpp v37, v24, v5 row_newbcast:13 row_mask:0xf bank_mask:0xf
    v_and_b32_dpp v38, v24, v6 row_newbcast:13 row_mask:0xf bank_mask:0xf
    v_and_b32_dpp v39, v24, v7 row_newbcast:13 row_mask:0xf bank_mask:0xf
    v_and_b32_dpp v40, v24, v4 row_newbcast:14 row_mask:0xf bank_mask:0xf
    v_and_b32_dpp v41, v24, v5 row_newbcast:14 row_mask:0xf bank_mask:0xf
    v_and_b32_dpp v42, v24, v6 row_newbcast:14 row_mask:0xf bank_mask:0xf
    v_and_b32_dpp v43, v24, v7 row_newbcast:14 row_mask:0xf bank_mask:0xf
    v_and_b32_dpp v44, v24, v4 row_newbcast:15 row_mask:0xf bank_mask:0xf
    v_and_b32_dpp v45, v24, v5 row_newbcast:15 row_mask:0xf bank_mask:0xf
    v_and_b32_dpp v46, v24, v6 row_newbcast:15 row_mask:0xf bank_mask:0xf
    v_and_b32_dpp v47, v24, v7 row_newbcast:15 row_mask:0xf bank_mask:0xf
    v_mfma_f32_16x16x32_bf16 v[20:23], v[32:35], v[144:147], v[20:23]
    s_waitcnt vmcnt(6)
    s_cmp_eq_u32 s57, 0
    s_cbranch_scc1 L_th126
    s_waitcnt vmcnt(5)
    s_cmp_lg_u32 s57, 2
    s_cbranch_scc1 L_th126
    s_waitcnt vmcnt(4)
L_th126:
    buffer_load_dwordx4 v[188:191], v3, s[48:51], s53 offen offset:3072 nt
    s_add_u32 s53, s53, 16384
    v_mfma_f32_16x16x32_bf16 v[20:23], v[36:39], v[148:151], v[20:23]
    s_waitcnt vmcnt(6)
    s_cmp_eq_u32 s57, 0
    s_cbranch_scc1 L_th127
    s_waitcnt vmcnt(5)
    s_cmp_lg_u32 s57, 2
    s_cbranch_scc1 L_th127
    s_waitcnt vmcnt(4)
L_th127:
    buffer_load_dwordx4 v[64:67], v3, s[48:51], s53 offen offset:0 nt
    s_waitcnt lgkmcnt(0)
    v_readfirstlane_b32 s57, v51
    v_add_u32 v48, 1, v48
    ds_write_b32 v49, v48
    ds_read_b32 v51, v50
    v_mfma_f32_16x16x32_bf16 v[20:23], v[40:43], v[152:155], v[20:23]
    s_waitcnt vmcnt(6)
    s_cmp_eq_u32 s57, 0
    s_cbranch_scc1 L_th128
    s_waitcnt vmcnt(5)
    s_cmp_lg_u32 s57, 2
    s_cbranch_scc1 L_th128
    s_waitcnt vmcnt(4)
L_th128:
    buffer_load_dwordx4 v[68:71], v3, s[48:51], s53 offen offset:1024 nt
    v_mfma_f32_16x16x32_bf16 v[20:23], v[44:47], v[156:159], v[20:23]
    v_and_b32_dpp v32, v25, v4 row_newbcast:0 row_mask:0xf bank_mask:0xf
    v_and_b32_dpp v33, v25, v5 row_newbcast:0 row_mask:0xf bank_mask:0xf
    v_and_b32_dpp v34, v25, v6 row_newbcast:0 row_mask:0xf bank_mask:0xf
    v_and_b32_dpp v35, v25, v7 row_newbcast:0 row_mask:0xf bank_mask:0xf
    v_and_b32_dpp v36, v25, v4 row_newbcast:1 row_mask:0xf bank_mask:0xf
    v_and_b32_dpp v37, v25, v5 row_newbcast:1 row_mask:0xf bank_mask:0xf
    v_and_b32_dpp v38, v25, v6 row_newbcast:1 row_mask:0xf bank_mask:0xf
    v_and_b32_dpp v39, v25, v7 row_newbcast:1 row_mask:0xf bank_mask:0xf
    v_and_b32_dpp v40, v25, v4 row_newbcast:2 row_mask:0xf bank_mask:0xf
    v_and_b32_dpp v41, v25, v5 row_newbcast:2 row_mask:0xf bank_mask:0xf
    v_and_b32_dpp v42, v25, v6 row_newbcast:2 row_mask:0xf bank_mask:0xf
    v_and_b32_dpp v43, v25, v7 row_newbcast:2 row_mask:0xf bank_mask:0xf
    v_and_b32_dpp v44, v25, v4 row_newbcast:3 row_mask:0xf bank_mask:0xf
    v_and_b32_dpp v45, v25, v5 row_newbcast:3 row_mask:0xf bank_mask:0xf
    v_and_b32_dpp v46, v25, v6 row_newbcast:3 row_mask:0xf bank_mask:0xf
    v_and_b32_dpp v47, v25, v7 row_newbcast:3 row_mask:0xf bank_mask:0xf
    v_mfma_f32_16x16x32_bf16 v[20:23], v[32:35], v[160:163], v[20:23]
    s_waitcnt vmcnt(6)
    s_cmp_eq_u32 s57, 0
    s_cbranch_scc1 L_th129
    s_waitcnt vmcnt(5)
    s_cmp_lg_u32 s57, 2
    s_cbranch_scc1 L_th129
    s_waitcnt vmcnt(4)
L_th129:
    buffer_load_dwordx4 v[72:75], v3, s[48:51], s53 offen offset:2048 nt
    v_mfma_f32_16x16x32_bf16 v[20:23], v[36:39], v[164:167], v[20:23]
    s_waitcnt vmcnt(6)
    s_cmp_eq_u32 s57, 0
    s_cbranch_scc1 L_th130
    s_waitcnt vmcnt(5)
    s_cmp_lg_u32 s57, 2
    s_cbranch_scc1 L_th130
    s_waitcnt vmcnt(4)
L_th130:
    buffer_load_dwordx4 v[76:79], v3, s[48:51], s53 offen offset:3072 nt
    s_add_u32 s53, s53, 16384
    v_mfma_f32_16x16x32_bf16 v[20:23], v[40:43], v[168:171], v[20:23]
    s_waitcnt vmcnt(6)
    s_cmp_eq_u32 s57, 0
    s_cbranch_scc1 L_th131
    s_waitcnt vmcnt(5)
    s_cmp_lg_u32 s57, 2
    s_cbranch_scc1 L_th131
    s_waitcnt vmcnt(4)
L_th131:
    buffer_load_dwordx4 v[80:83], v3, s[48:51], s53 offen offset:0 nt
    s_waitcnt lgkmcnt(0)
    v_readfirstlane_b32 s57, v51
    v_add_u32 v48, 1, v48
    ds_write_b32 v49, v48
    ds_read_b32 v51, v50
    v_mfma_f32_16x16x32_bf16 v[20:23], v[44:47], v[172:175], v[20:23]
    s_waitcnt vmcnt(6)
    s_cmp_eq_u32 s57, 0
    s_cbranch_scc1 L_th132
    s_waitcnt vmcnt(5)
    s_cmp_lg_u32 s57, 2
    s_cbranch_scc1 L_th132
    s_waitcnt vmcnt(4)
L_th132:
    buffer_load_dwordx4 v[84:87], v3, s[48:51], s53 offen offset:1024 nt
    v_and_b32_dpp v32, v25, v4 row_newbcast:4 row_mask:0xf bank_mask:0xf
    v_and_b32_dpp v33, v25, v5 row_newbcast:4 row_mask:0xf bank_mask:0xf
    v_and_b32_dpp v34, v25, v6 row_newbcast:4 row_mask:0xf bank_mask:0xf
    v_and_b32_dpp v35, v25, v7 row_newbcast:4 row_mask:0xf bank_mask:0xf
    v_and_b32_dpp v36, v25, v4 row_newbcast:5 row_mask:0xf bank_mask:0xf
    v_and_b32_dpp v37, v25, v5 row_newbcast:5 row_mask:0xf bank_mask:0xf
    v_and_b32_dpp v38, v25, v6 row_newbcast:5 row_mask:0xf bank_mask:0xf
    v_and_b32_dpp v39, v25, v7 row_newbcast:5 row_mask:0xf bank_mask:0xf
    v_and_b32_dpp v40, v25, v4 row_newbcast:6 row_mask:0xf bank_mask:0xf
    v_and_b32_dpp v41, v25, v5 row_newbcast:6 row_mask:0xf bank_mask:0xf
    v_and_b32_dpp v42, v25, v6 row_newbcast:6 row_mask:0xf bank_mask:0xf
    v_and_b32_dpp v43, v25, v7 row_newbcast:6 row_mask:0xf bank_mask:0xf
    v_and_b32_dpp v44, v25, v4 row_newbcast:7 row_mask:0xf bank_mask:0xf
    v_and_b32_dpp v45, v25, v5 row_newbcast:7 row_mask:0xf bank_mask:0xf
    v_and_b32_dpp v46, v25, v6 row_newbcast:7 row_mask:0xf bank_mask:0xf
    v_and_b32_dpp v47, v25, v7 row_newbcast:7 row_mask:0xf bank_mask:0xf
    v_mfma_f32_16x16x32_bf16 v[20:23], v[32:35], v[176:179], v[20:23]
    s_waitcnt vmcnt(6)
    s_cmp_eq_u32 s57, 0
    s_cbranch_scc1 L_th133
    s_waitcnt vmcnt(5)
    s_cmp_lg_u32 s57, 2
    s_cbranch_scc1 L_th133
    s_waitcnt vmcnt(4)
L_th133:
    buffer_load_dwordx4 v[88:91], v3, s[48:51], s53 offen offset:2048 nt
    v_mfma_f32_16x16x32_bf16 v[20:23], v[36:39], v[180:183], v[20:23]
    s_waitcnt vmcnt(6)
    s_cmp_eq_u32 s57, 0
    s_cbranch_scc1 L_th134
    s_waitcnt vmcnt(5)
    s_cmp_lg_u32 s57, 2
    s_cbranch_scc1 L_th134
    s_waitcnt vmcnt(4)
L_th134:
    buffer_load_dwordx4 v[92:95], v3, s[48:51], s53 offen offset:3072 nt
    s_add_u32 s53, s53, 16384
    v_mfma_f32_16x16x32_bf16 v[20:23], v[40:43], v[184:187], v[20:23]
    s_waitcnt vmcnt(6)
    s_cmp_eq_u32 s57, 0
    s_cbranch_scc1 L_th135
    s_waitcnt vmcnt(5)
    s_cmp_lg_u32 s57, 2
    s_cbranch_scc1 L_th135
    s_waitcnt vmcnt(4)
L_th135:
    buffer_load_dwordx4 v[96:99], v3, s[48:51], s53 offen offset:0 nt
    s_waitcnt lgkmcnt(0)
    v_readfirstlane_b32 s57, v51
    v_add_u32 v48, 1, v48
    ds_write_b32 v49, v48
    ds_read_b32 v51, v50
    v_mfma_f32_16x16x32_bf16 v[20:23], v[44:47], v[188:191], v[20:23]
    v_and_b32_dpp v32, v25, v4 row_newbcast:8 row_mask:0xf bank_mask:0xf
    v_and_b32_dpp v33, v25, v5 row_newbcast:8 row_mask:0xf bank_mask:0xf
    v_and_b32_dpp v34, v25, v6 row_newbcast:8 row_mask:0xf bank_mask:0xf
    v_and_b32_dpp v35, v25, v7 row_newbcast:8 row_mask:0xf bank_mask:0xf
    v_and_b32_dpp v36, v25, v4 row_newbcast:9 row_mask:0xf bank_mask:0xf
    v_and_b32_dpp v37, v25, v5 row_newbcast:9 row_mask:0xf bank_mask:0xf
    v_and_b32_dpp v38, v25, v6 row_newbcast:9 row_mask:0xf bank_mask:0xf
    v_and_b32_dpp v39, v25, v7 row_newbcast:9 row_mask:0xf bank_mask:0xf
    v_and_b32_dpp v40, v25, v4 row_newbcast:10 row_mask:0xf bank_mask:0xf
    v_and_b32_dpp v41, v25, v5 row_newbcast:10 row_mask:0xf bank_mask:0xf
    v_and_b32_dpp v42, v25, v6 row_newbcast:10 row_mask:0xf bank_mask:0xf
    v_and_b32_dpp v43, v25, v7 row_newbcast:10 row_mask:0xf bank_mask:0xf
    v_and_b32_dpp v44, v25, v4 row_newbcast:11 row_mask:0xf bank_mask:0xf
    v_and_b32_dpp v45, v25, v5 row_newbcast:11 row_mask:0xf bank_mask:0xf
    v_and_b32_dpp v46, v25, v6 row_newbcast:11 row_mask:0xf bank_mask:0xf
    v_and_b32_dpp v47, v25, v7 row_newbcast:11 row_mask:0xf bank_mask:0xf
    v_mfma_f32_16x16x32_bf16 v[20:23], v[32:35], v[64:67], v[20:23]
    s_waitcnt vmcnt(6)
    s_cmp_eq_u32 s57, 0
    s_cbranch_scc1 L_th136
    s_waitcnt vmcnt(5)
    s_cmp_lg_u32 s57, 2
    s_cbranch_scc1 L_th136
    s_waitcnt vmcnt(4)
L_th136:
    buffer_load_dwordx4 v[100:103], v3, s[48:51], s53 offen offset:1024 nt
    v_mfma_f32_16x16x32_bf16 v[20:23], v[36:39], v[68:71], v[20:23]
    s_waitcnt vmcnt(6)
    s_cmp_eq_u32 s57, 0
    s_cbranch_scc1 L_th137
    s_waitcnt vmcnt(5)
    s_cmp_lg_u32 s57, 2
    s_cbranch_scc1 L_th137
    s_waitcnt vmcnt(4)
L_th137:
    buffer_load_dwordx4 v[104:107], v3, s[48:51], s53 offen offset:2048 nt
    v_mfma_f32_16x16x32_bf16 v[20:23], v[40:43], v[72:75], v[20:23]
    s_waitcnt vmcnt(6)
    s_cmp_eq_u32 s57, 0
    s_cbranch_scc1 L_th138
    s_waitcnt vmcnt(5)
    s_cmp_lg_u32 s57, 2
    s_cbranch_scc1 L_th138
    s_waitcnt vmcnt(4)
L_th138:
    buffer_load_dwordx4 v[108:111], v3, s[48:51], s53 offen offset:3072 nt
    s_add_u32 s53, s53, 16384
    v_mfma_f32_16x16x32_bf16 v[20:23], v[44:47], v[76:79], v[20:23]
    s_waitcnt vmcnt(6)
    s_cmp_eq_u32 s57, 0
    s_cbranch_scc1 L_th139
    s_waitcnt vmcnt(5)
    s_cmp_lg_u32 s57, 2
    s_cbranch_scc1 L_th139
    s_waitcnt vmcnt(4)
L_th139:
    buffer_load_dwordx4 v[112:115], v3, s[48:51], s53 offen offset:0 nt
    s_waitcnt lgkmcnt(0)
    v_readfirstlane_b32 s57, v51
    v_add_u32 v48, 1, v48
    ds_write_b32 v49, v48
    ds_read_b32 v51, v50
    v_and_b32_dpp v32, v25, v4 row_newbcast:12 row_mask:0xf bank_mask:0xf
    v_and_b32_dpp v33, v25, v5 row_newbcast:12 row_mask:0xf bank_mask:0xf
    v_and_b32_dpp v34, v25, v6 row_newbcast:12 row_mask:0xf bank_mask:0xf
    v_and_b32_dpp v35, v25, v7 row_newbcast:12 row_mask:0xf bank_mask:0xf
    v_and_b32_dpp v36, v25, v4 row_newbcast:13 row_mask:0xf bank_mask:0xf
    v_and_b32_dpp v37, v25, v5 row_newbcast:13 row_mask:0xf bank_mask:0xf
    v_and_b32_dpp v38, v25, v6 row_newbcast:13 row_mask:0xf bank_mask:0xf
    v_and_b32_dpp v39, v25, v7 row_newbcast:13 row_mask:0xf bank_mask:0xf
    v_and_b32_dpp v40, v25, v4 row_newbcast:14 row_mask:0xf bank_mask:0xf
    v_and_b32_dpp v41, v25, v5 row_newbcast:14 row_mask:0xf bank_mask:0xf
    v_and_b32_dpp v42, v25, v6 row_newbcast:14 row_mask:0xf bank_mask:0xf
    v_and_b32_dpp v43, v25, v7 row_newbcast:14 row_mask:0xf bank_mask:0xf
    v_and_b32_dpp v44, v25, v4 row_newbcast:15 row_mask:0xf bank_mask:0xf
    v_and_b32_dpp v45, v25, v5 row_newbcast:15 row_mask:0xf bank_mask:0xf
    v_and_b32_dpp v46, v25, v6 row_newbcast:15 row_mask:0xf bank_mask:0xf
    v_and_b32_dpp v47, v25, v7 row_newbcast:15 row_mask:0xf bank_mask:0xf
    v_mfma_f32_16x16x32_bf16 v[20:23], v[32:35], v[80:83], v[20:23]
    s_waitcnt vmcnt(6)
    s_cmp_eq_u32 s57, 0
    s_cbranch_scc1 L_th140
    s_waitcnt vmcnt(5)
    s_cmp_lg_u32 s57, 2
    s_cbranch_scc1 L_th140
    s_waitcnt vmcnt(4)
L_th140:
    buffer_load_dwordx4 v[116:119], v3, s[48:51], s53 offen offset:1024 nt
    v_mfma_f32_16x16x32_bf16 v[20:23], v[36:39], v[84:87], v[20:23]
    s_waitcnt vmcnt(6)
    s_cmp_eq_u32 s57, 0
    s_cbranch_scc1 L_th141
    s_waitcnt vmcnt(5)
    s_cmp_lg_u32 s57, 2
    s_cbranch_scc1 L_th141
    s_waitcnt vmcnt(4)
L_th141:
    buffer_load_dwordx4 v[120:123], v3, s[48:51], s53 offen offset:2048 nt
    v_mfma_f32_16x16x32_bf16 v[20:23], v[40:43], v[88:91], v[20:23]
    v_mfma_f32_16x16x32_bf16 v[20:23], v[44:47], v[92:95], v[20:23]
    s_waitcnt vmcnt(6)
    s_cmp_eq_u32 s57, 0
    s_cbranch_scc1 L_th142
    s_waitcnt vmcnt(5)
    s_cmp_lg_u32 s57, 2
    s_cbranch_scc1 L_th142
    s_waitcnt vmcnt(4)
L_th142:
    buffer_load_dwordx4 v[124:127], v3, s[48:51], s53 offen offset:3072 nt
    s_add_u32 s53, s53, 16384
    s_mov_b32 s54, 14
L_vloop:
    s_waitcnt lgkmcnt(0)
    v_sub_f32 v24, v26, v29
    v_sub_f32 v25, v27, v29
    v_mul_f32 v24, 0x3fb8aa3b, v24
    v_mul_f32 v25, 0x3fb8aa3b, v25
    v_exp_f32 v24, v24
    v_exp_f32 v25, v25
    v_add_u32 v28, 512, v28
    v_mul_f32 v24, v24, v30
    v_mul_f32 v25, v25, v30
    v_cvt_pk_bf16_f32 v24, v24, v24
    v_cvt_pk_bf16_f32 v25, v25, v25
    ds_read2st64_b32 v[26:27], v28 offset0:0 offset1:1
    s_nop 0
    v_and_b32_dpp v32, v24, v4 row_newbcast:0 row_mask:0xf bank_mask:0xf
    v_and_b32_dpp v33, v24, v5 row_newbcast:0 row_mask:0xf bank_mask:0xf
    v_and_b32_dpp v34, v24, v6 row_newbcast:0 row_mask:0xf bank_mask:0xf
    v_and_b32_dpp v35, v24, v7 row_newbcast:0 row_mask:0xf bank_mask:0xf
    v_and_b32_dpp v36, v24, v4 row_newbcast:1 row_mask:0xf bank_mask:0xf
    v_and_b32_dpp v37, v24, v5 row_newbcast:1 row_mask:0xf bank_mask:0xf
    v_and_b32_dpp v38, v24, v6 row_newbcast:1 row_mask:0xf bank_mask:0xf
    v_and_b32_dpp v39, v24, v7 row_newbcast:1 row_mask:0xf bank_mask:0xf
    v_and_b32_dpp v40, v24, v4 row_newbcast:2 row_mask:0xf bank_mask:0xf
    v_and_b32_dpp v41, v24, v5 row_newbcast:2 row_mask:0xf bank_mask:0xf
    v_and_b32_dpp v42, v24, v6 row_newbcast:2 row_mask:0xf bank_mask:0xf
    v_and_b32_dpp v43, v24, v7 row_newbcast:2 row_mask:0xf bank_mask:0xf
    v_and_b32_dpp v44, v24, v4 row_newbcast:3 row_mask:0xf bank_mask:0xf
    v_and_b32_dpp v45, v24, v5 row_newbcast:3 row_mask:0xf bank_mask:0xf
    v_and_b32_dpp v46, v24, v6 row_newbcast:3 row_mask:0xf bank_mask:0xf
    v_and_b32_dpp v47, v24, v7 row_newbcast:3 row_mask:0xf bank_mask:0xf
    v_mfma_f32_16x16x32_bf16 v[20:23], v[32:35], v[96:99], v[20:23]
    s_waitcnt vmcnt(6)
    s_cmp_eq_u32 s57, 0
    s_cbranch_scc1 L_th143
    s_waitcnt vmcnt(5)
    s_cmp_lg_u32 s57, 2
    s_cbranch_scc1 L_th143
    s_waitcnt vmcnt(4)
L_th143:
    buffer_load_dwordx4 v[128:131], v3, s[48:51], s53 offen offset:0 nt
    s_waitcnt lgkmcnt(0)
    v_readfirstlane_b32 s57, v51
    v_add_u32 v48, 1, v48
    ds_write_b32 v49, v48
    ds_read_b32 v51, v50
    v_mfma_f32_16x16x32_bf16 v[20:23], v[36:39], v[100:103], v[20:23]
    s_waitcnt vmcnt(6)
    s_cmp_eq_u32 s57, 0
    s_cbranch_scc1 L_th144
    s_waitcnt vmcnt(5)
    s_cmp_lg_u32 s57, 2
    s_cbranch_scc1 L_th144
    s_waitcnt vmcnt(4)
L_th144:
    buffer_load_dwordx4 v[132:135], v3, s[48:51], s53 offen offset:1024 nt
    v_mfma_f32_16x16x32_bf16 v[20:23], v[40:43], v[104:107], v[20:23]
    s_waitcnt vmcnt(6)
    s_cmp_eq_u32 s57, 0
    s_cbranch_scc1 L_th145
    s_waitcnt vmcnt(5)
    s_cmp_lg_u32 s57, 2
    s_cbranch_scc1 L_th145
    s_waitcnt vmcnt(4)
L_th145:
    buffer_load_dwordx4 v[136:139], v3, s[48:51], s53 offen offset:2048 nt
    v_mfma_f32_16x16x32_bf16 v[20:23], v[44:47], v[108:111], v[20:23]
    s_waitcnt vmcnt(6)
    s_cmp_eq_u32 s57, 0
    s_cbranch_scc1 L_th146
    s_waitcnt vmcnt(5)
    s_cmp_lg_u32 s57, 2
    s_cbranch_scc1 L_th146
    s_waitcnt vmcnt(4)
L_th146:
    buffer_load_dwordx4 v[140:143], v3, s[48:51], s53 offen offset:3072 nt
    s_add_u32 s53, s53, 16384
    v_and_b32_dpp v32, v24, v4 row_newbcast:4 row_mask:0xf bank_mask:0xf
    v_and_b32_dpp v33, v24, v5 row_newbcast:4 row_mask:0xf bank_mask:0xf
    v_and_b32_dpp v34, v24, v6 row_newbcast:4 row_mask:0xf bank_mask:0xf
    v_and_b32_dpp v35, v24, v7 row_newbcast:4 row_mask:0xf bank_mask:0xf
    v_and_b32_dpp v36, v24, v4 row_newbcast:5 row_mask:0xf bank_mask:0xf
    v_and_b32_dpp v37, v24, v5 row_newbcast:5 row_mask:0xf bank_mask:0xf
    v_and_b32_dpp v38, v24, v6 row_newbcast:5 row_mask:0xf bank_mask:0xf
    v_and_b32_dpp v39, v24, v7 row_newbcast:5 row_mask:0xf bank_mask:0xf
    v_and_b32_dpp v40, v24, v4 row_newbcast:6 row_mask:0xf bank_mask:0xf
    v_and_b32_dpp v41, v24, v5 row_newbcast:6 row_mask:0xf bank_mask:0xf
    v_and_b32_dpp v42, v24, v6 row_newbcast:6 row_mask:0xf bank_mask:0xf
    v_and_b32_dpp v43, v24, v7 row_newbcast:6 row_mask:0xf bank_mask:0xf
    v_and_b32_dpp v44, v24, v4 row_newbcast:7 row_mask:0xf bank_mask:0xf
    v_and_b32_dpp v45, v24, v5 row_newbcast:7 row_mask:0xf bank_mask:0xf
    v_and_b32_dpp v46, v24, v6 row_newbcast:7 row_mask:0xf bank_mask:0xf
    v_and_b32_dpp v47, v24, v7 row_newbcast:7 row_mask:0xf bank_mask:0xf
    v_mfma_f32_16x16x32_bf16 v[20:23], v[32:35], v[112:115], v[20:23]
    s_waitcnt vmcnt(6)
    s_cmp_eq_u32 s57, 0
    s_cbranch_scc1 L_th147
    s_waitcnt vmcnt(5)
    s_cmp_lg_u32 s57, 2
    s_cbranch_scc1 L_th147
    s_waitcnt vmcnt(4)
L_th147:
    buffer_load_dwordx4 v[144:147], v3, s[48:51], s53 offen offset:0 nt
    s_waitcnt lgkmcnt(0)
    v_readfirstlane_b32 s57, v51
    v_add_u32 v48, 1, v48
    ds_write_b32 v49, v48
    ds_read_b32 v51, v50
    v_mfma_f32_16x16x32_bf16 v[20:23], v[36:39], v[116:119], v[20:23]
    s_waitcnt vmcnt(6)
    s_cmp_eq_u32 s57, 0
    s_cbranch_scc1 L_th148
    s_waitcnt vmcnt(5)
    s_cmp_lg_u32 s57, 2
    s_cbranch_scc1 L_th148
    s_waitcnt vmcnt(4)
L_th148:
    buffer_load_dwordx4 v[148:151], v3, s[48:51], s53 offen offset:1024 nt
    v_mfma_f32_16x16x32_bf16 v[20:23], v[40:43], v[120:123], v[20:23]
    s_waitcnt vmcnt(6)
    s_cmp_eq_u32 s57, 0
    s_cbranch_scc1 L_th149
    s_waitcnt vmcnt(5)
    s_cmp_lg_u32 s57, 2
    s_cbranch_scc1 L_th149
    s_waitcnt vmcnt(4)
L_th149:
    buffer_load_dwordx4 v[152:155], v3, s[48:51], s53 offen offset:2048 nt
    v_mfma_f32_16x16x32_bf16 v[20:23], v[44:47], v[124:127], v[20:23]
    s_waitcnt vmcnt(6)
    s_cmp_eq_u32 s57, 0
    s_cbranch_scc1 L_th150
    s_waitcnt vmcnt(5)
    s_cmp_lg_u32 s57, 2
    s_cbranch_scc1 L_th150
    s_waitcnt vmcnt(4)
L_th150:
    buffer_load_dwordx4 v[156:159], v3, s[48:51], s53 offen offset:3072 nt
    s_add_u32 s53, s53, 16384
    v_and_b32_dpp v32, v24, v4 row_newbcast:8 row_mask:0xf bank_mask:0xf
    v_and_b32_dpp v33, v24, v5 row_newbcast:8 row_mask:0xf bank_mask:0xf
    v_and_b32_dpp v34, v24, v6 row_newbcast:8 row_mask:0xf bank_mask:0xf
    v_and_b32_dpp v35, v24, v7 row_newbcast:8 row_mask:0xf bank_mask:0xf
    v_and_b32_dpp v36, v24, v4 row_newbcast:9 row_mask:0xf bank_mask:0xf
    v_and_b32_dpp v37, v24, v5 row_newbcast:9 row_mask:0xf bank_mask:0xf
    v_and_b32_dpp v38, v24, v6 row_newbcast:9 row_mask:0xf bank_mask:0xf
    v_and_b32_dpp v39, v24, v7 row_newbcast:9 row_mask:0xf bank_mask:0xf
    v_and_b32_dpp v40, v24, v4 row_newbcast:10 row_mask:0xf bank_mask:0xf
    v_and_b32_dpp v41, v24, v5 row_newbcast:10 row_mask:0xf bank_mask:0xf
    v_and_b32_dpp v42, v24, v6 row_newbcast:10 row_mask:0xf bank_mask:0xf
    v_and_b32_dpp v43, v24, v7 row_newbcast:10 row_mask:0xf bank_mask:0xf
    v_and_b32_dpp v44, v24, v4 row_newbcast:11 row_mask:0xf bank_mask:0xf
    v_and_b32_dpp v45, v24, v5 row_newbcast:11 row_mask:0xf bank_mask:0xf
    v_and_b32_dpp v46, v24, v6 row_newbcast:11 row_mask:0xf bank_mask:0xf
    v_and_b32_dpp v47, v24, v7 row_newbcast:11 row_mask:0xf bank_mask:0xf
    v_mfma_f32_16x16x32_bf16 v[20:23], v[32:35], v[128:131], v[20:23]
    s_waitcnt vmcnt(6)
    s_cmp_eq_u32 s57, 0
    s_cbranch_scc1 L_th151
    s_waitcnt vmcnt(5)
    s_cmp_lg_u32 s57, 2
    s_cbranch_scc1 L_th151
    s_waitcnt vmcnt(4)
L_th151:
    buffer_load_dwordx4 v[160:163], v3, s[48:51], s53 offen offset:0 nt
    s_waitcnt lgkmcnt(0)
    v_readfirstlane_b32 s57, v51
    v_add_u32 v48, 1, v48
    ds_write_b32 v49, v48
    ds_read_b32 v51, v50
    v_mfma_f32_16x16x32_bf16 v[20:23], v[36:39], v[132:135], v[20:23]
    s_waitcnt vmcnt(6)
    s_cmp_eq_u32 s57, 0
    s_cbranch_scc1 L_th152
    s_waitcnt vmcnt(5)
    s_cmp_lg_u32 s57, 2
    s_cbranch_scc1 L_th152
    s_waitcnt vmcnt(4)
L_th152:
    buffer_load_dwordx4 v[164:167], v3, s[48:51], s53 offen offset:1024 nt
    v_mfma_f32_16x16x32_bf16 v[20:23], v[40:43], v[136:139], v[20:23]
    s_waitcnt vmcnt(6)
    s_cmp_eq_u32 s57, 0
    s_cbranch_scc1 L_th153
    s_waitcnt vmcnt(5)
    s_cmp_lg_u32 s57, 2
    s_cbranch_scc1 L_th153
    s_waitcnt vmcnt(4)
L_th153:
    buffer_load_dwordx4 v[168:171], v3, s[48:51], s53 offen offset:2048 nt
    v_mfma_f32_16x16x32_bf16 v[20:23], v[44:47], v[140:143], v[20:23]
    s_waitcnt vmcnt(6)
    s_cmp_eq_u32 s57, 0
    s_cbranch_scc1 L_th154
    s_waitcnt vmcnt(5)
    s_cmp_lg_u32 s57, 2
    s_cbranch_scc1 L_th154
    s_waitcnt vmcnt(4)
L_th154:
    buffer_load_dwordx4 v[172:175], v3, s[48:51], s53 offen offset:3072 nt
    s_add_u32 s53, s53, 16384
    v_and_b32_dpp v32, v24, v4 row_newbcast:12 row_mask:0xf bank_mask:0xf
    v_and_b32_dpp v33, v24, v5 row_newbcast:12 row_mask:0xf bank_mask:0xf
    v_and_b32_dpp v34, v24, v6 row_newbcast:12 row_mask:0xf bank_mask:0xf
    v_and_b32_dpp v35, v24, v7 row_newbcast:12 row_mask:0xf bank_mask:0xf
    v_and_b32_dpp v36, v24, v4 row_newbcast:13 row_mask:0xf bank_mask:0xf
    v_and_b32_dpp v37, v24, v5 row_newbcast:13 row_mask:0xf bank_mask:0xf
    v_and_b32_dpp v38, v24, v6 row_newbcast:13 row_mask:0xf bank_mask:0xf
    v_and_b32_dpp v39, v24, v7 row_newbcast:13 row_mask:0xf bank_mask:0xf
    v_and_b32_dpp v40, v24, v4 row_newbcast:14 row_mask:0xf bank_mask:0xf
    v_and_b32_dpp v41, v24, v5 row_newbcast:14 row_mask:0xf bank_mask:0xf
    v_and_b32_dpp v42, v24, v6 row_newbcast:14 row_mask:0xf bank_mask:0xf
    v_and_b32_dpp v43, v24, v7 row_newbcast:14 row_mask:0xf bank_mask:0xf
    v_and_b32_dpp v44, v24, v4 row_newbcast:15 row_mask:0xf bank_mask:0xf
    v_and_b32_dpp v45, v24, v5 row_newbcast:15 row_mask:0xf bank_mask:0xf
    v_and_b32_dpp v46, v24, v6 row_newbcast:15 row_mask:0xf bank_mask:0xf
    v_and_b32_dpp v47, v24, v7 row_newbcast:15 row_mask:0xf bank_mask:0xf
    v_mfma_f32_16x16x32_bf16 v[20:23], v[32:35], v[144:147], v[20:23]
    s_waitcnt vmcnt(6)
    s_cmp_eq_u32 s57, 0
    s_cbranch_scc1 L_th155
    s_waitcnt vmcnt(5)
    s_cmp_lg_u32 s57, 2
    s_cbranch_scc1 L_th155
    s_waitcnt vmcnt(4)
L_th155:
    buffer_load_dwordx4 v[176:179], v3, s[48:51], s53 offen offset:0 nt
    s_waitcnt lgkmcnt(0)
    v_readfirstlane_b32 s57, v51
    v_add_u32 v48, 1, v48
    ds_write_b32 v49, v48
    ds_read_b32 v51, v50
    v_mfma_f32_16x16x32_bf16 v[20:23], v[36:39], v[148:151], v[20:23]
    s_waitcnt vmcnt(6)
    s_cmp_eq_u32 s57, 0
    s_cbranch_scc1 L_th156
    s_waitcnt vmcnt(5)
    s_cmp_lg_u32 s57, 2
    s_cbranch_scc1 L_th156
    s_waitcnt vmcnt(4)
L_th156:
    buffer_load_dwordx4 v[180:183], v3, s[48:51], s53 offen offset:1024 nt
    v_mfma_f32_16x16x32_bf16 v[20:23], v[40:43], v[152:155], v[20:23]
    s_waitcnt vmcnt(6)
    s_cmp_eq_u32 s57, 0
    s_cbranch_scc1 L_th157
    s_waitcnt vmcnt(5)
    s_cmp_lg_u32 s57, 2
    s_cbranch_scc1 L_th157
    s_waitcnt vmcnt(4)
L_th157:
    buffer_load_dwordx4 v[184:187], v3, s[48:51], s53 offen offset:2048 nt
    v_mfma_f32_16x16x32_bf16 v[20:23], v[44:47], v[156:159], v[20:23]
    s_waitcnt vmcnt(6)
    s_cmp_eq_u32 s57, 0
    s_cbranch_scc1 L_th158
    s_waitcnt vmcnt(5)
    s_cmp_lg_u32 s57, 2
    s_cbranch_scc1 L_th158
    s_waitcnt vmcnt(4)
L_th158:
    buffer_load_dwordx4 v[188:191], v3, s[48:51], s53 offen offset:3072 nt
    s_add_u32 s53, s53, 16384
    v_and_b32_dpp v32, v25, v4 row_newbcast:0 row_mask:0xf bank_mask:0xf
    v_and_b32_dpp v33, v25, v5 row_newbcast:0 row_mask:0xf bank_mask:0xf
    v_and_b32_dpp v34, v25, v6 row_newbcast:0 row_mask:0xf bank_mask:0xf
    v_and_b32_dpp v35, v25, v7 row_newbcast:0 row_mask:0xf bank_mask:0xf
    v_and_b32_dpp v36, v25, v4 row_newbcast:1 row_mask:0xf bank_mask:0xf
    v_and_b32_dpp v37, v25, v5 row_newbcast:1 row_mask:0xf bank_mask:0xf
    v_and_b32_dpp v38, v25, v6 row_newbcast:1 row_mask:0xf bank_mask:0xf
    v_and_b32_dpp v39, v25, v7 row_newbcast:1 row_mask:0xf bank_mask:0xf
    v_and_b32_dpp v40, v25, v4 row_newbcast:2 row_mask:0xf bank_mask:0xf
    v_and_b32_dpp v41, v25, v5 row_newbcast:2 row_mask:0xf bank_mask:0xf
    v_and_b32_dpp v42, v25, v6 row_newbcast:2 row_mask:0xf bank_mask:0xf
    v_and_b32_dpp v43, v25, v7 row_newbcast:2 row_mask:0xf bank_mask:0xf
    v_and_b32_dpp v44, v25, v4 row_newbcast:3 row_mask:0xf bank_mask:0xf
    v_and_b32_dpp v45, v25, v5 row_newbcast:3 row_mask:0xf bank_mask:0xf
    v_and_b32_dpp v46, v25, v6 row_newbcast:3 row_mask:0xf bank_mask:0xf
    v_and_b32_dpp v47, v25, v7 row_newbcast:3 row_mask:0xf bank_mask:0xf
    v_mfma_f32_16x16x32_bf16 v[20:23], v[32:35], v[160:163], v[20:23]
    s_waitcnt vmcnt(6)
    s_cmp_eq_u32 s57, 0
    s_cbranch_scc1 L_th159
    s_waitcnt vmcnt(5)
    s_cmp_lg_u32 s57, 2
    s_cbranch_scc1 L_th159
    s_waitcnt vmcnt(4)
L_th159:
    buffer_load_dwordx4 v[64:67], v3, s[48:51], s53 offen offset:0 nt
    s_waitcnt lgkmcnt(0)
    v_readfirstlane_b32 s57, v51
    v_add_u32 v48, 1, v48
    ds_write_b32 v49, v48
    ds_read_b32 v51, v50
    v_mfma_f32_16x16x32_bf16 v[20:23], v[36:39], v[164:167], v[20:23]
    s_waitcnt vmcnt(6)
    s_cmp_eq_u32 s57, 0
    s_cbranch_scc1 L_th160
    s_waitcnt vmcnt(5)
    s_cmp_lg_u32 s57, 2
    s_cbranch_scc1 L_th160
    s_waitcnt vmcnt(4)
L_th160:
    buffer_load_dwordx4 v[68:71], v3, s[48:51], s53 offen offset:1024 nt
    v_mfma_f32_16x16x32_bf16 v[20:23], v[40:43], v[168:171], v[20:23]
    s_waitcnt vmcnt(6)
    s_cmp_eq_u32 s57, 0
    s_cbranch_scc1 L_th161
    s_waitcnt vmcnt(5)
    s_cmp_lg_u32 s57, 2
    s_cbranch_scc1 L_th161
    s_waitcnt vmcnt(4)
L_th161:
    buffer_load_dwordx4 v[72:75], v3, s[48:51], s53 offen offset:2048 nt
    v_mfma_f32_16x16x32_bf16 v[20:23], v[44:47], v[172:175], v[20:23]
    s_waitcnt vmcnt(6)
    s_cmp_eq_u32 s57, 0
    s_cbranch_scc1 L_th162
    s_waitcnt vmcnt(5)
    s_cmp_lg_u32 s57, 2
    s_cbranch_scc1 L_th162
    s_waitcnt vmcnt(4)
L_th162:
    buffer_load_dwordx4 v[76:79], v3, s[48:51], s53 offen offset:3072 nt
    s_add_u32 s53, s53, 16384
    v_and_b32_dpp v32, v25, v4 row_newbcast:4 row_mask:0xf bank_mask:0xf
    v_and_b32_dpp v33, v25, v5 row_newbcast:4 row_mask:0xf bank_mask:0xf
    v_and_b32_dpp v34, v25, v6 row_newbcast:4 row_mask:0xf bank_mask:0xf
    v_and_b32_dpp v35, v25, v7 row_newbcast:4 row_mask:0xf bank_mask:0xf
    v_and_b32_dpp v36, v25, v4 row_newbcast:5 row_mask:0xf bank_mask:0xf
    v_and_b32_dpp v37, v25, v5 row_newbcast:5 row_mask:0xf bank_mask:0xf
    v_and_b32_dpp v38, v25, v6 row_newbcast:5 row_mask:0xf bank_mask:0xf
    v_and_b32_dpp v39, v25, v7 row_newbcast:5 row_mask:0xf bank_mask:0xf
    v_and_b32_dpp v40, v25, v4 row_newbcast:6 row_mask:0xf bank_mask:0xf
    v_and_b32_dpp v41, v25, v5 row_newbcast:6 row_mask:0xf bank_mask:0xf
    v_and_b32_dpp v42, v25, v6 row_newbcast:6 row_mask:0xf bank_mask:0xf
    v_and_b32_dpp v43, v25, v7 row_newbcast:6 row_mask:0xf bank_mask:0xf
    v_and_b32_dpp v44, v25, v4 row_newbcast:7 row_mask:0xf bank_mask:0xf
    v_and_b32_dpp v45, v25, v5 row_newbcast:7 row_mask:0xf bank_mask:0xf
    v_and_b32_dpp v46, v25, v6 row_newbcast:7 row_mask:0xf bank_mask:0xf
    v_and_b32_dpp v47, v25, v7 row_newbcast:7 row_mask:0xf bank_mask:0xf
    v_mfma_f32_16x16x32_bf16 v[20:23], v[32:35], v[176:179], v[20:23]
    s_waitcnt vmcnt(6)
    s_cmp_eq_u32 s57, 0
    s_cbranch_scc1 L_th163
    s_waitcnt vmcnt(5)
    s_cmp_lg_u32 s57, 2
    s_cbranch_scc1 L_th163
    s_waitcnt vmcnt(4)
L_th163:
    buffer_load_dwordx4 v[80:83], v3, s[48:51], s53 offen offset:0 nt
    s_waitcnt lgkmcnt(0)
    v_readfirstlane_b32 s57, v51
    v_add_u32 v48, 1, v48
    ds_write_b32 v49, v48
    ds_read_b32 v51, v50
    v_mfma_f32_16x16x32_bf16 v[20:23], v[36:39], v[180:183], v[20:23]
    s_waitcnt vmcnt(6)
    s_cmp_eq_u32 s57, 0
    s_cbranch_scc1 L_th164
    s_waitcnt vmcnt(5)
    s_cmp_lg_u32 s57, 2
    s_cbranch_scc1 L_th164
    s_waitcnt vmcnt(4)
L_th164:
    buffer_load_dwordx4 v[84:87], v3, s[48:51], s53 offen offset:1024 nt
    v_mfma_f32_16x16x32_bf16 v[20:23], v[40:43], v[184:187], v[20:23]
    s_waitcnt vmcnt(6)
    s_cmp_eq_u32 s57, 0
    s_cbranch_scc1 L_th165
    s_waitcnt vmcnt(5)
    s_cmp_lg_u32 s57, 2
    s_cbranch_scc1 L_th165
    s_waitcnt vmcnt(4)
L_th165:
    buffer_load_dwordx4 v[88:91], v3, s[48:51], s53 offen offset:2048 nt
    v_mfma_f32_16x16x32_bf16 v[20:23], v[44:47], v[188:191], v[20:23]
    s_waitcnt vmcnt(6)
    s_cmp_eq_u32 s57, 0
    s_cbranch_scc1 L_th166
    s_waitcnt vmcnt(5)
    s_cmp_lg_u32 s57, 2
    s_cbranch_scc1 L_th166
    s_waitcnt vmcnt(4)
L_th166:
    buffer_load_dwordx4 v[92:95], v3, s[48:51], s53 offen offset:3072 nt
    s_add_u32 s53, s53, 16384
    v_and_b32_dpp v32, v25, v4 row_newbcast:8 row_mask:0xf bank_mask:0xf
    v_and_b32_dpp v33, v25, v5 row_newbcast:8 row_mask:0xf bank_mask:0xf
    v_and_b32_dpp v34, v25, v6 row_newbcast:8 row_mask:0xf bank_mask:0xf
    v_and_b32_dpp v35, v25, v7 row_newbcast:8 row_mask:0xf bank_mask:0xf
    v_and_b32_dpp v36, v25, v4 row_newbcast:9 row_mask:0xf bank_mask:0xf
    v_and_b32_dpp v37, v25, v5 row_newbcast:9 row_mask:0xf bank_mask:0xf
    v_and_b32_dpp v38, v25, v6 row_newbcast:9 row_mask:0xf bank_mask:0xf
    v_and_b32_dpp v39, v25, v7 row_newbcast:9 row_mask:0xf bank_mask:0xf
    v_and_b32_dpp v40, v25, v4 row_newbcast:10 row_mask:0xf bank_mask:0xf
    v_and_b32_dpp v41, v25, v5 row_newbcast:10 row_mask:0xf bank_mask:0xf
    v_and_b32_dpp v42, v25, v6 row_newbcast:10 row_mask:0xf bank_mask:0xf
    v_and_b32_dpp v43, v25, v7 row_newbcast:10 row_mask:0xf bank_mask:0xf
    v_and_b32_dpp v44, v25, v4 row_newbcast:11 row_mask:0xf bank_mask:0xf
    v_and_b32_dpp v45, v25, v5 row_newbcast:11 row_mask:0xf bank_mask:0xf
    v_and_b32_dpp v46, v25, v6 row_newbcast:11 row_mask:0xf bank_mask:0xf
    v_and_b32_dpp v47, v25, v7 row_newbcast:11 row_mask:0xf bank_mask:0xf
    v_mfma_f32_16x16x32_bf16 v[20:23], v[32:35], v[64:67], v[20:23]
    s_waitcnt vmcnt(6)
    s_cmp_eq_u32 s57, 0
    s_cbranch_scc1 L_th167
    s_waitcnt vmcnt(5)
    s_cmp_lg_u32 s57, 2
    s_cbranch_scc1 L_th167
    s_waitcnt vmcnt(4)
L_th167:
    buffer_load_dwordx4 v[96:99], v3, s[48:51], s53 offen offset:0 nt
    s_waitcnt lgkmcnt(0)
    v_readfirstlane_b32 s57, v51
    v_add_u32 v48, 1, v48
    ds_write_b32 v49, v48
    ds_read_b32 v51, v50
    v_mfma_f32_16x16x32_bf16 v[20:23], v[36:39], v[68:71], v[20:23]
    s_waitcnt vmcnt(6)
    s_cmp_eq_u32 s57, 0
    s_cbranch_scc1 L_th168
    s_waitcnt vmcnt(5)
    s_cmp_lg_u32 s57, 2
    s_cbranch_scc1 L_th168
    s_waitcnt vmcnt(4)
L_th168:
    buffer_load_dwordx4 v[100:103], v3, s[48:51], s53 offen offset:1024 nt
    v_mfma_f32_16x16x32_bf16 v[20:23], v[40:43], v[72:75], v[20:23]
    s_waitcnt vmcnt(6)
    s_cmp_eq_u32 s57, 0
    s_cbranch_scc1 L_th169
    s_waitcnt vmcnt(5)
    s_cmp_lg_u32 s57, 2
    s_cbranch_scc1 L_th169
    s_waitcnt vmcnt(4)
L_th169:
    buffer_load_dwordx4 v[104:107], v3, s[48:51], s53 offen offset:2048 nt
    v_mfma_f32_16x16x32_bf16 v[20:23], v[44:47], v[76:79], v[20:23]
    s_waitcnt vmcnt(6)
    s_cmp_eq_u32 s57, 0
    s_cbranch_scc1 L_th170
    s_waitcnt vmcnt(5)
    s_cmp_lg_u32 s57, 2
    s_cbranch_scc1 L_th170
    s_waitcnt vmcnt(4)
L_th170:
    buffer_load_dwordx4 v[108:111], v3, s[48:51], s53 offen offset:3072 nt
    s_add_u32 s53, s53, 16384
    v_and_b32_dpp v32, v25, v4 row_newbcast:12 row_mask:0xf bank_mask:0xf
    v_and_b32_dpp v33, v25, v5 row_newbcast:12 row_mask:0xf bank_mask:0xf
    v_and_b32_dpp v34, v25, v6 row_newbcast:12 row_mask:0xf bank_mask:0xf
    v_and_b32_dpp v35, v25, v7 row_newbcast:12 row_mask:0xf bank_mask:0xf
    v_and_b32_dpp v36, v25, v4 row_newbcast:13 row_mask:0xf bank_mask:0xf
    v_and_b32_dpp v37, v25, v5 row_newbcast:13 row_mask:0xf bank_mask:0xf
    v_and_b32_dpp v38, v25, v6 row_newbcast:13 row_mask:0xf bank_mask:0xf
    v_and_b32_dpp v39, v25, v7 row_newbcast:13 row_mask:0xf bank_mask:0xf
    v_and_b32_dpp v40, v25, v4 row_newbcast:14 row_mask:0xf bank_mask:0xf
    v_and_b32_dpp v41, v25, v5 row_newbcast:14 row_mask:0xf bank_mask:0xf
    v_and_b32_dpp v42, v25, v6 row_newbcast:14 row_mask:0xf bank_mask:0xf
    v_and_b32_dpp v43, v25, v7 row_newbcast:14 row_mask:0xf bank_mask:0xf
    v_and_b32_dpp v44, v25, v4 row_newbcast:15 row_mask:0xf bank_mask:0xf
    v_and_b32_dpp v45, v25, v5 row_newbcast:15 row_mask:0xf bank_mask:0xf
    v_and_b32_dpp v46, v25, v6 row_newbcast:15 row_mask:0xf bank_mask:0xf
    v_and_b32_dpp v47, v25, v7 row_newbcast:15 row_mask:0xf bank_mask:0xf
    v_mfma_f32_16x16x32_bf16 v[20:23], v[32:35], v[80:83], v[20:23]
    s_waitcnt vmcnt(6)
    s_cmp_eq_u32 s57, 0
    s_cbranch_scc1 L_th171
    s_waitcnt vmcnt(5)
    s_cmp_lg_u32 s57, 2
    s_cbranch_scc1 L_th171
    s_waitcnt vmcnt(4)
L_th171:
    buffer_load_dwordx4 v[112:115], v3, s[48:51], s53 offen offset:0 nt
    s_waitcnt lgkmcnt(0)
    v_readfirstlane_b32 s57, v51
    v_add_u32 v48, 1, v48
    ds_write_b32 v49, v48
    ds_read_b32 v51, v50
    v_mfma_f32_16x16x32_bf16 v[20:23], v[36:39], v[84:87], v[20:23]
    s_waitcnt vmcnt(6)
    s_cmp_eq_u32 s57, 0
    s_cbranch_scc1 L_th172
    s_waitcnt vmcnt(5)
    s_cmp_lg_u32 s57, 2
    s_cbranch_scc1 L_th172
    s_waitcnt vmcnt(4)
L_th172:
    buffer_load_dwordx4 v[116:119], v3, s[48:51], s53 offen offset:1024 nt
    v_mfma_f32_16x16x32_bf16 v[20:23], v[40:43], v[88:91], v[20:23]
    s_waitcnt vmcnt(6)
    s_cmp_eq_u32 s57, 0
    s_cbranch_scc1 L_th173
    s_waitcnt vmcnt(5)
    s_cmp_lg_u32 s57, 2
    s_cbranch_scc1 L_th173
    s_waitcnt vmcnt(4)
L_th173:
    buffer_load_dwordx4 v[120:123], v3, s[48:51], s53 offen offset:2048 nt
    v_mfma_f32_16x16x32_bf16 v[20:23], v[44:47], v[92:95], v[20:23]
    s_waitcnt vmcnt(6)
    s_cmp_eq_u32 s57, 0
    s_cbranch_scc1 L_th174
    s_waitcnt vmcnt(5)
    s_cmp_lg_u32 s57, 2
    s_cbranch_scc1 L_th174
    s_waitcnt vmcnt(4)
L_th174:
    buffer_load_dwordx4 v[124:127], v3, s[48:51], s53 offen offset:3072 nt
    s_add_u32 s53, s53, 16384
    s_sub_u32 s54, s54, 1
    s_cmp_lg_u32 s54, 0
    s_cbranch_scc1 L_vloop
    s_waitcnt lgkmcnt(0)
    v_sub_f32 v24, v26, v29
    v_sub_f32 v25, v27, v29
    v_mul_f32 v24, 0x3fb8aa3b, v24
    v_mul_f32 v25, 0x3fb8aa3b, v25
    v_exp_f32 v24, v24
    v_exp_f32 v25, v25
    v_add_u32 v28, 512, v28
    v_mul_f32 v24, v24, v30
    v_mul_f32 v25, v25, v30
    v_cvt_pk_bf16_f32 v24, v24, v24
    v_cvt_pk_bf16_f32 v25, v25, v25
    ds_read2st64_b32 v[26:27], v28 offset0:0 offset1:1
    s_nop 0
    v_and_b32_dpp v32, v24, v4 row_newbcast:0 row_mask:0xf bank_mask:0xf
    v_and_b32_dpp v33, v24, v5 row_newbcast:0 row_mask:0xf bank_mask:0xf
    v_and_b32_dpp v34, v24, v6 row_newbcast:0 row_mask:0xf bank_mask:0xf
    v_and_b32_dpp v35, v24, v7 row_newbcast:0 row_mask:0xf bank_mask:0xf
    v_and_b32_dpp v36, v24, v4 row_newbcast:1 row_mask:0xf bank_mask:0xf
    v_and_b32_dpp v37, v24, v5 row_newbcast:1 row_mask:0xf bank_mask:0xf
    v_and_b32_dpp v38, v24, v6 row_newbcast:1 row_mask:0xf bank_mask:0xf
    v_and_b32_dpp v39, v24, v7 row_newbcast:1 row_mask:0xf bank_mask:0xf
    v_and_b32_dpp v40, v24, v4 row_newbcast:2 row_mask:0xf bank_mask:0xf
    v_and_b32_dpp v41, v24, v5 row_newbcast:2 row_mask:0xf bank_mask:0xf
    v_and_b32_dpp v42, v24, v6 row_newbcast:2 row_mask:0xf bank_mask:0xf
    v_and_b32_dpp v43, v24, v7 row_newbcast:2 row_mask:0xf bank_mask:0xf
    v_and_b32_dpp v44, v24, v4 row_newbcast:3 row_mask:0xf bank_mask:0xf
    v_and_b32_dpp v45, v24, v5 row_newbcast:3 row_mask:0xf bank_mask:0xf
    v_and_b32_dpp v46, v24, v6 row_newbcast:3 row_mask:0xf bank_mask:0xf
    v_and_b32_dpp v47, v24, v7 row_newbcast:3 row_mask:0xf bank_mask:0xf
    v_mfma_f32_16x16x32_bf16 v[20:23], v[32:35], v[96:99], v[20:23]
    s_waitcnt vmcnt(6)
    s_cmp_eq_u32 s57, 0
    s_cbranch_scc1 L_th175
    s_waitcnt vmcnt(5)
    s_cmp_lg_u32 s57, 2
    s_cbranch_scc1 L_th175
    s_waitcnt vmcnt(4)
L_th175:
    buffer_load_dwordx4 v[128:131], v3, s[48:51], s53 offen offset:0 nt
    s_waitcnt lgkmcnt(0)
    v_readfirstlane_b32 s57, v51
    v_add_u32 v48, 1, v48
    ds_write_b32 v49, v48
    ds_read_b32 v51, v50
    v_mfma_f32_16x16x32_bf16 v[20:23], v[36:39], v[100:103], v[20:23]
    s_waitcnt vmcnt(6)
    s_cmp_eq_u32 s57, 0
    s_cbranch_scc1 L_th176
    s_waitcnt vmcnt(5)
    s_cmp_lg_u32 s57, 2
    s_cbranch_scc1 L_th176
    s_waitcnt vmcnt(4)
L_th176:
    buffer_load_dwordx4 v[132:135], v3, s[48:51], s53 offen offset:1024 nt
    v_mfma_f32_16x16x32_bf16 v[20:23], v[40:43], v[104:107], v[20:23]
    s_waitcnt vmcnt(6)
    s_cmp_eq_u32 s57, 0
    s_cbranch_scc1 L_th177
    s_waitcnt vmcnt(5)
    s_cmp_lg_u32 s57, 2
    s_cbranch_scc1 L_th177
    s_waitcnt vmcnt(4)
L_th177:
    buffer_load_dwordx4 v[136:139], v3, s[48:51], s53 offen offset:2048 nt
    v_mfma_f32_16x16x32_bf16 v[20:23], v[44:47], v[108:111], v[20:23]
    s_waitcnt vmcnt(6)
    s_cmp_eq_u32 s57, 0
    s_cbranch_scc1 L_th178
    s_waitcnt vmcnt(5)
    s_cmp_lg_u32 s57, 2
    s_cbranch_scc1 L_th178
    s_waitcnt vmcnt(4)
L_th178:
    buffer_load_dwordx4 v[140:143], v3, s[48:51], s53 offen offset:3072 nt
    s_add_u32 s53, s53, 16384
    v_and_b32_dpp v32, v24, v4 row_newbcast:4 row_mask:0xf bank_mask:0xf
    v_and_b32_dpp v33, v24, v5 row_newbcast:4 row_mask:0xf bank_mask:0xf
    v_and_b32_dpp v34, v24, v6 row_newbcast:4 row_mask:0xf bank_mask:0xf
    v_and_b32_dpp v35, v24, v7 row_newbcast:4 row_mask:0xf bank_mask:0xf
    v_and_b32_dpp v36, v24, v4 row_newbcast:5 row_mask:0xf bank_mask:0xf
    v_and_b32_dpp v37, v24, v5 row_newbcast:5 row_mask:0xf bank_mask:0xf
    v_and_b32_dpp v38, v24, v6 row_newbcast:5 row_mask:0xf bank_mask:0xf
    v_and_b32_dpp v39, v24, v7 row_newbcast:5 row_mask:0xf bank_mask:0xf
    v_and_b32_dpp v40, v24, v4 row_newbcast:6 row_mask:0xf bank_mask:0xf
    v_and_b32_dpp v41, v24, v5 row_newbcast:6 row_mask:0xf bank_mask:0xf
    v_and_b32_dpp v42, v24, v6 row_newbcast:6 row_mask:0xf bank_mask:0xf
    v_and_b32_dpp v43, v24, v7 row_newbcast:6 row_mask:0xf bank_mask:0xf
    v_and_b32_dpp v44, v24, v4 row_newbcast:7 row_mask:0xf bank_mask:0xf
    v_and_b32_dpp v45, v24, v5 row_newbcast:7 row_mask:0xf bank_mask:0xf
    v_and_b32_dpp v46, v24, v6 row_newbcast:7 row_mask:0xf bank_mask:0xf
    v_and_b32_dpp v47, v24, v7 row_newbcast:7 row_mask:0xf bank_mask:0xf
    v_mfma_f32_16x16x32_bf16 v[20:23], v[32:35], v[112:115], v[20:23]
    s_waitcnt vmcnt(6)
    s_cmp_eq_u32 s57, 0
    s_cbranch_scc1 L_th179
    s_waitcnt vmcnt(5)
    s_cmp_lg_u32 s57, 2
    s_cbranch_scc1 L_th179
    s_waitcnt vmcnt(4)
L_th179:
    buffer_load_dwordx4 v[144:147], v3, s[48:51], s53 offen offset:0 nt
    s_waitcnt lgkmcnt(0)
    v_readfirstlane_b32 s57, v51
    v_add_u32 v48, 1, v48
    ds_write_b32 v49, v48
    ds_read_b32 v51, v50
    v_mfma_f32_16x16x32_bf16 v[20:23], v[36:39], v[116:119], v[20:23]
    s_waitcnt vmcnt(6)
    s_cmp_eq_u32 s57, 0
    s_cbranch_scc1 L_th180
    s_waitcnt vmcnt(5)
    s_cmp_lg_u32 s57, 2
    s_cbranch_scc1 L_th180
    s_waitcnt vmcnt(4)
L_th180:
    buffer_load_dwordx4 v[148:151], v3, s[48:51], s53 offen offset:1024 nt
    v_mfma_f32_16x16x32_bf16 v[20:23], v[40:43], v[120:123], v[20:23]
    s_waitcnt vmcnt(6)
    s_cmp_eq_u32 s57, 0
    s_cbranch_scc1 L_th181
    s_waitcnt vmcnt(5)
    s_cmp_lg_u32 s57, 2
    s_cbranch_scc1 L_th181
    s_waitcnt vmcnt(4)
L_th181:
    buffer_load_dwordx4 v[152:155], v3, s[48:51], s53 offen offset:2048 nt
    v_mfma_f32_16x16x32_bf16 v[20:23], v[44:47], v[124:127], v[20:23]
    s_waitcnt vmcnt(6)
    s_cmp_eq_u32 s57, 0
    s_cbranch_scc1 L_th182
    s_waitcnt vmcnt(5)
    s_cmp_lg_u32 s57, 2
    s_cbranch_scc1 L_th182
    s_waitcnt vmcnt(4)
L_th182:
    buffer_load_dwordx4 v[156:159], v3, s[48:51], s53 offen offset:3072 nt
    s_add_u32 s53, s53, 16384
    v_and_b32_dpp v32, v24, v4 row_newbcast:8 row_mask:0xf bank_mask:0xf
    v_and_b32_dpp v33, v24, v5 row_newbcast:8 row_mask:0xf bank_mask:0xf
    v_and_b32_dpp v34, v24, v6 row_newbcast:8 row_mask:0xf bank_mask:0xf
    v_and_b32_dpp v35, v24, v7 row_newbcast:8 row_mask:0xf bank_mask:0xf
    v_and_b32_dpp v36, v24, v4 row_newbcast:9 row_mask:0xf bank_mask:0xf
    v_and_b32_dpp v37, v24, v5 row_newbcast:9 row_mask:0xf bank_mask:0xf
    v_and_b32_dpp v38, v24, v6 row_newbcast:9 row_mask:0xf bank_mask:0xf
    v_and_b32_dpp v39, v24, v7 row_newbcast:9 row_mask:0xf bank_mask:0xf
    v_and_b32_dpp v40, v24, v4 row_newbcast:10 row_mask:0xf bank_mask:0xf
    v_and_b32_dpp v41, v24, v5 row_newbcast:10 row_mask:0xf bank_mask:0xf
    v_and_b32_dpp v42, v24, v6 row_newbcast:10 row_mask:0xf bank_mask:0xf
    v_and_b32_dpp v43, v24, v7 row_newbcast:10 row_mask:0xf bank_mask:0xf
    v_and_b32_dpp v44, v24, v4 row_newbcast:11 row_mask:0xf bank_mask:0xf
    v_and_b32_dpp v45, v24, v5 row_newbcast:11 row_mask:0xf bank_mask:0xf
    v_and_b32_dpp v46, v24, v6 row_newbcast:11 row_mask:0xf bank_mask:0xf
    v_and_b32_dpp v47, v24, v7 row_newbcast:11 row_mask:0xf bank_mask:0xf
    v_mfma_f32_16x16x32_bf16 v[20:23], v[32:35], v[128:131], v[20:23]
    s_waitcnt vmcnt(6)
    s_cmp_eq_u32 s57, 0
    s_cbranch_scc1 L_th183
    s_waitcnt vmcnt(5)
    s_cmp_lg_u32 s57, 2
    s_cbranch_scc1 L_th183
    s_waitcnt vmcnt(4)
L_th183:
    buffer_load_dwordx4 v[160:163], v3, s[48:51], s53 offen offset:0 nt
    s_waitcnt lgkmcnt(0)
    v_readfirstlane_b32 s57, v51
    v_add_u32 v48, 1, v48
    ds_write_b32 v49, v48
    ds_read_b32 v51, v50
    v_mfma_f32_16x16x32_bf16 v[20:23], v[36:39], v[132:135], v[20:23]
    s_waitcnt vmcnt(6)
    s_cmp_eq_u32 s57, 0
    s_cbranch_scc1 L_th184
    s_waitcnt vmcnt(5)
    s_cmp_lg_u32 s57, 2
    s_cbranch_scc1 L_th184
    s_waitcnt vmcnt(4)
L_th184:
    buffer_load_dwordx4 v[164:167], v3, s[48:51], s53 offen offset:1024 nt
    v_mfma_f32_16x16x32_bf16 v[20:23], v[40:43], v[136:139], v[20:23]
    s_waitcnt vmcnt(6)
    s_cmp_eq_u32 s57, 0
    s_cbranch_scc1 L_th185
    s_waitcnt vmcnt(5)
    s_cmp_lg_u32 s57, 2
    s_cbranch_scc1 L_th185
    s_waitcnt vmcnt(4)
L_th185:
    buffer_load_dwordx4 v[168:171], v3, s[48:51], s53 offen offset:2048 nt
    v_mfma_f32_16x16x32_bf16 v[20:23], v[44:47], v[140:143], v[20:23]
    s_waitcnt vmcnt(6)
    s_cmp_eq_u32 s57, 0
    s_cbranch_scc1 L_th186
    s_waitcnt vmcnt(5)
    s_cmp_lg_u32 s57, 2
    s_cbranch_scc1 L_th186
    s_waitcnt vmcnt(4)
L_th186:
    buffer_load_dwordx4 v[172:175], v3, s[48:51], s53 offen offset:3072 nt
    s_add_u32 s53, s53, 16384
    v_and_b32_dpp v32, v24, v4 row_newbcast:12 row_mask:0xf bank_mask:0xf
    v_and_b32_dpp v33, v24, v5 row_newbcast:12 row_mask:0xf bank_mask:0xf
    v_and_b32_dpp v34, v24, v6 row_newbcast:12 row_mask:0xf bank_mask:0xf
    v_and_b32_dpp v35, v24, v7 row_newbcast:12 row_mask:0xf bank_mask:0xf
    v_and_b32_dpp v36, v24, v4 row_newbcast:13 row_mask:0xf bank_mask:0xf
    v_and_b32_dpp v37, v24, v5 row_newbcast:13 row_mask:0xf bank_mask:0xf
    v_and_b32_dpp v38, v24, v6 row_newbcast:13 row_mask:0xf bank_mask:0xf
    v_and_b32_dpp v39, v24, v7 row_newbcast:13 row_mask:0xf bank_mask:0xf
    v_and_b32_dpp v40, v24, v4 row_newbcast:14 row_mask:0xf bank_mask:0xf
    v_and_b32_dpp v41, v24, v5 row_newbcast:14 row_mask:0xf bank_mask:0xf
    v_and_b32_dpp v42, v24, v6 row_newbcast:14 row_mask:0xf bank_mask:0xf
    v_and_b32_dpp v43, v24, v7 row_newbcast:14 row_mask:0xf bank_mask:0xf
    v_and_b32_dpp v44, v24, v4 row_newbcast:15 row_mask:0xf bank_mask:0xf
    v_and_b32_dpp v45, v24, v5 row_newbcast:15 row_mask:0xf bank_mask:0xf
    v_and_b32_dpp v46, v24, v6 row_newbcast:15 row_mask:0xf bank_mask:0xf
    v_and_b32_dpp v47, v24, v7 row_newbcast:15 row_mask:0xf bank_mask:0xf
    v_mfma_f32_16x16x32_bf16 v[20:23], v[32:35], v[144:147], v[20:23]
    s_waitcnt vmcnt(6)
    s_cmp_eq_u32 s57, 0
    s_cbranch_scc1 L_th187
    s_waitcnt vmcnt(5)
    s_cmp_lg_u32 s57, 2
    s_cbranch_scc1 L_th187
    s_waitcnt vmcnt(4)
L_th187:
    buffer_load_dwordx4 v[176:179], v3, s[48:51], s53 offen offset:0 nt
    s_waitcnt lgkmcnt(0)
    v_readfirstlane_b32 s57, v51
    v_add_u32 v48, 1, v48
    ds_write_b32 v49, v48
    ds_read_b32 v51, v50
    v_mfma_f32_16x16x32_bf16 v[20:23], v[36:39], v[148:151], v[20:23]
    s_waitcnt vmcnt(6)
    s_cmp_eq_u32 s57, 0
    s_cbranch_scc1 L_th188
    s_waitcnt vmcnt(5)
    s_cmp_lg_u32 s57, 2
    s_cbranch_scc1 L_th188
    s_waitcnt vmcnt(4)
L_th188:
    buffer_load_dwordx4 v[180:183], v3, s[48:51], s53 offen offset:1024 nt
    v_mfma_f32_16x16x32_bf16 v[20:23], v[40:43], v[152:155], v[20:23]
    s_waitcnt vmcnt(6)
    s_cmp_eq_u32 s57, 0
    s_cbranch_scc1 L_th189
    s_waitcnt vmcnt(5)
    s_cmp_lg_u32 s57, 2
    s_cbranch_scc1 L_th189
    s_waitcnt vmcnt(4)
L_th189:
    buffer_load_dwordx4 v[184:187], v3, s[48:51], s53 offen offset:2048 nt
    v_mfma_f32_16x16x32_bf16 v[20:23], v[44:47], v[156:159], v[20:23]
    s_waitcnt vmcnt(6)
    s_cmp_eq_u32 s57, 0
    s_cbranch_scc1 L_th190
    s_waitcnt vmcnt(5)
    s_cmp_lg_u32 s57, 2
    s_cbranch_scc1 L_th190
    s_waitcnt vmcnt(4)
L_th190:
    buffer_load_dwordx4 v[188:191], v3, s[48:51], s53 offen offset:3072 nt
    s_add_u32 s53, s53, 16384
    v_and_b32_dpp v32, v25, v4 row_newbcast:0 row_mask:0xf bank_mask:0xf
    v_and_b32_dpp v33, v25, v5 row_newbcast:0 row_mask:0xf bank_mask:0xf
    v_and_b32_dpp v34, v25, v6 row_newbcast:0 row_mask:0xf bank_mask:0xf
    v_and_b32_dpp v35, v25, v7 row_newbcast:0 row_mask:0xf bank_mask:0xf
    v_and_b32_dpp v36, v25, v4 row_newbcast:1 row_mask:0xf bank_mask:0xf
    v_and_b32_dpp v37, v25, v5 row_newbcast:1 row_mask:0xf bank_mask:0xf
    v_and_b32_dpp v38, v25, v6 row_newbcast:1 row_mask:0xf bank_mask:0xf
    v_and_b32_dpp v39, v25, v7 row_newbcast:1 row_mask:0xf bank_mask:0xf
    v_and_b32_dpp v40, v25, v4 row_newbcast:2 row_mask:0xf bank_mask:0xf
    v_and_b32_dpp v41, v25, v5 row_newbcast:2 row_mask:0xf bank_mask:0xf
    v_and_b32_dpp v42, v25, v6 row_newbcast:2 row_mask:0xf bank_mask:0xf
    v_and_b32_dpp v43, v25, v7 row_newbcast:2 row_mask:0xf bank_mask:0xf
    v_and_b32_dpp v44, v25, v4 row_newbcast:3 row_mask:0xf bank_mask:0xf
    v_and_b32_dpp v45, v25, v5 row_newbcast:3 row_mask:0xf bank_mask:0xf
    v_and_b32_dpp v46, v25, v6 row_newbcast:3 row_mask:0xf bank_mask:0xf
    v_and_b32_dpp v47, v25, v7 row_newbcast:3 row_mask:0xf bank_mask:0xf
    v_mfma_f32_16x16x32_bf16 v[20:23], v[32:35], v[160:163], v[20:23]
    s_waitcnt vmcnt(6)
    s_cmp_eq_u32 s57, 0
    s_cbranch_scc1 L_th191
    s_waitcnt vmcnt(5)
    s_cmp_lg_u32 s57, 2
    s_cbranch_scc1 L_th191
    s_waitcnt vmcnt(4)
L_th191:
    buffer_load_dwordx4 v[64:67], v3, s[48:51], s53 offen offset:0 nt
    s_waitcnt lgkmcnt(0)
    v_readfirstlane_b32 s57, v51
    v_add_u32 v48, 1, v48
    ds_write_b32 v49, v48
    ds_read_b32 v51, v50
    v_mfma_f32_16x16x32_bf16 v[20:23], v[36:39], v[164:167], v[20:23]
    s_waitcnt vmcnt(6)
    s_cmp_eq_u32 s57, 0
    s_cbranch_scc1 L_th192
    s_waitcnt vmcnt(5)
    s_cmp_lg_u32 s57, 2
    s_cbranch_scc1 L_th192
    s_waitcnt vmcnt(4)
L_th192:
    buffer_load_dwordx4 v[68:71], v3, s[48:51], s53 offen offset:1024 nt
    v_mfma_f32_16x16x32_bf16 v[20:23], v[40:43], v[168:171], v[20:23]
    s_waitcnt vmcnt(6)
    s_cmp_eq_u32 s57, 0
    s_cbranch_scc1 L_th193
    s_waitcnt vmcnt(5)
    s_cmp_lg_u32 s57, 2
    s_cbranch_scc1 L_th193
    s_waitcnt vmcnt(4)
L_th193:
    buffer_load_dwordx4 v[72:75], v3, s[48:51], s53 offen offset:2048 nt
    v_mfma_f32_16x16x32_bf16 v[20:23], v[44:47], v[172:175], v[20:23]
    s_waitcnt vmcnt(6)
    s_cmp_eq_u32 s57, 0
    s_cbranch_scc1 L_th194
    s_waitcnt vmcnt(5)
    s_cmp_lg_u32 s57, 2
    s_cbranch_scc1 L_th194
    s_waitcnt vmcnt(4)
L_th194:
    buffer_load_dwordx4 v[76:79], v3, s[48:51], s53 offen offset:3072 nt
    s_add_u32 s53, s53, 16384
    v_and_b32_dpp v32, v25, v4 row_newbcast:4 row_mask:0xf bank_mask:0xf
    v_and_b32_dpp v33, v25, v5 row_newbcast:4 row_mask:0xf bank_mask:0xf
    v_and_b32_dpp v34, v25, v6 row_newbcast:4 row_mask:0xf bank_mask:0xf
    v_and_b32_dpp v35, v25, v7 row_newbcast:4 row_mask:0xf bank_mask:0xf
    v_and_b32_dpp v36, v25, v4 row_newbcast:5 row_mask:0xf bank_mask:0xf
    v_and_b32_dpp v37, v25, v5 row_newbcast:5 row_mask:0xf bank_mask:0xf
    v_and_b32_dpp v38, v25, v6 row_newbcast:5 row_mask:0xf bank_mask:0xf
    v_and_b32_dpp v39, v25, v7 row_newbcast:5 row_mask:0xf bank_mask:0xf
    v_and_b32_dpp v40, v25, v4 row_newbcast:6 row_mask:0xf bank_mask:0xf
    v_and_b32_dpp v41, v25, v5 row_newbcast:6 row_mask:0xf bank_mask:0xf
    v_and_b32_dpp v42, v25, v6 row_newbcast:6 row_mask:0xf bank_mask:0xf
    v_and_b32_dpp v43, v25, v7 row_newbcast:6 row_mask:0xf bank_mask:0xf
    v_and_b32_dpp v44, v25, v4 row_newbcast:7 row_mask:0xf bank_mask:0xf
    v_and_b32_dpp v45, v25, v5 row_newbcast:7 row_mask:0xf bank_mask:0xf
    v_and_b32_dpp v46, v25, v6 row_newbcast:7 row_mask:0xf bank_mask:0xf
    v_and_b32_dpp v47, v25, v7 row_newbcast:7 row_mask:0xf bank_mask:0xf
    v_mfma_f32_16x16x32_bf16 v[20:23], v[32:35], v[176:179], v[20:23]
    s_waitcnt vmcnt(6)
    s_cmp_eq_u32 s57, 0
    s_cbranch_scc1 L_th195
    s_waitcnt vmcnt(5)
    s_cmp_lg_u32 s57, 2
    s_cbranch_scc1 L_th195
    s_waitcnt vmcnt(4)
L_th195:
    buffer_load_dwordx4 v[80:83], v3, s[48:51], s53 offen offset:0 nt
    s_waitcnt lgkmcnt(0)
    v_readfirstlane_b32 s57, v51
    v_add_u32 v48, 1, v48
    ds_write_b32 v49, v48
    ds_read_b32 v51, v50
    v_mfma_f32_16x16x32_bf16 v[20:23], v[36:39], v[180:183], v[20:23]
    s_waitcnt vmcnt(6)
    s_cmp_eq_u32 s57, 0
    s_cbranch_scc1 L_th196
    s_waitcnt vmcnt(5)
    s_cmp_lg_u32 s57, 2
    s_cbranch_scc1 L_th196
    s_waitcnt vmcnt(4)
L_th196:
    buffer_load_dwordx4 v[84:87], v3, s[48:51], s53 offen offset:1024 nt
    v_mfma_f32_16x16x32_bf16 v[20:23], v[40:43], v[184:187], v[20:23]
    s_waitcnt vmcnt(6)
    s_cmp_eq_u32 s57, 0
    s_cbranch_scc1 L_th197
    s_waitcnt vmcnt(5)
    s_cmp_lg_u32 s57, 2
    s_cbranch_scc1 L_th197
    s_waitcnt vmcnt(4)
L_th197:
    buffer_load_dwordx4 v[88:91], v3, s[48:51], s53 offen offset:2048 nt
    v_mfma_f32_16x16x32_bf16 v[20:23], v[44:47], v[188:191], v[20:23]
    s_waitcnt vmcnt(6)
    s_cmp_eq_u32 s57, 0
    s_cbranch_scc1 L_th198
    s_waitcnt vmcnt(5)
    s_cmp_lg_u32 s57, 2
    s_cbranch_scc1 L_th198
    s_waitcnt vmcnt(4)
L_th198:
    buffer_load_dwordx4 v[92:95], v3, s[48:51], s53 offen offset:3072 nt
    s_add_u32 s53, s53, 16384
    v_and_b32_dpp v32, v25, v4 row_newbcast:8 row_mask:0xf bank_mask:0xf
    v_and_b32_dpp v33, v25, v5 row_newbcast:8 row_mask:0xf bank_mask:0xf
    v_and_b32_dpp v34, v25, v6 row_newbcast:8 row_mask:0xf bank_mask:0xf
    v_and_b32_dpp v35, v25, v7 row_newbcast:8 row_mask:0xf bank_mask:0xf
    v_and_b32_dpp v36, v25, v4 row_newbcast:9 row_mask:0xf bank_mask:0xf
    v_and_b32_dpp v37, v25, v5 row_newbcast:9 row_mask:0xf bank_mask:0xf
    v_and_b32_dpp v38, v25, v6 row_newbcast:9 row_mask:0xf bank_mask:0xf
    v_and_b32_dpp v39, v25, v7 row_newbcast:9 row_mask:0xf bank_mask:0xf
    v_and_b32_dpp v40, v25, v4 row_newbcast:10 row_mask:0xf bank_mask:0xf
    v_and_b32_dpp v41, v25, v5 row_newbcast:10 row_mask:0xf bank_mask:0xf
    v_and_b32_dpp v42, v25, v6 row_newbcast:10 row_mask:0xf bank_mask:0xf
    v_and_b32_dpp v43, v25, v7 row_newbcast:10 row_mask:0xf bank_mask:0xf
    v_and_b32_dpp v44, v25, v4 row_newbcast:11 row_mask:0xf bank_mask:0xf
    v_and_b32_dpp v45, v25, v5 row_newbcast:11 row_mask:0xf bank_mask:0xf
    v_and_b32_dpp v46, v25, v6 row_newbcast:11 row_mask:0xf bank_mask:0xf
    v_and_b32_dpp v47, v25, v7 row_newbcast:11 row_mask:0xf bank_mask:0xf
    v_mfma_f32_16x16x32_bf16 v[20:23], v[32:35], v[64:67], v[20:23]
    s_waitcnt vmcnt(6)
    v_mfma_f32_16x16x32_bf16 v[20:23], v[36:39], v[68:71], v[20:23]
    s_waitcnt vmcnt(5)
    v_mfma_f32_16x16x32_bf16 v[20:23], v[40:43], v[72:75], v[20:23]
    s_waitcnt vmcnt(4)
    v_mfma_f32_16x16x32_bf16 v[20:23], v[44:47], v[76:79], v[20:23]
    v_and_b32_dpp v32, v25, v4 row_newbcast:12 row_mask:0xf bank_mask:0xf
    v_and_b32_dpp v33, v25, v5 row_newbcast:12 row_mask:0xf bank_mask:0xf
    v_and_b32_dpp v34, v25, v6 row_newbcast:12 row_mask:0xf bank_mask:0xf
    v_and_b32_dpp v35, v25, v7 row_newbcast:12 row_mask:0xf bank_mask:0xf
    v_and_b32_dpp v36, v25, v4 row_newbcast:13 row_mask:0xf bank_mask:0xf
    v_and_b32_dpp v37, v25, v5 row_newbcast:13 row_mask:0xf bank_mask:0xf
    v_and_b32_dpp v38, v25, v6 row_newbcast:13 row_mask:0xf bank_mask:0xf
    v_and_b32_dpp v39, v25, v7 row_newbcast:13 row_mask:0xf bank_mask:0xf
    v_and_b32_dpp v40, v25, v4 row_newbcast:14 row_mask:0xf bank_mask:0xf
    v_and_b32_dpp v41, v25, v5 row_newbcast:14 row_mask:0xf bank_mask:0xf
    v_and_b32_dpp v42, v25, v6 row_newbcast:14 row_mask:0xf bank_mask:0xf
    v_and_b32_dpp v43, v25, v7 row_newbcast:14 row_mask:0xf bank_mask:0xf
    v_and_b32_dpp v44, v25, v4 row_newbcast:15 row_mask:0xf bank_mask:0xf
    v_and_b32_dpp v45, v25, v5 row_newbcast:15 row_mask:0xf bank_mask:0xf
    v_and_b32_dpp v46, v25, v6 row_newbcast:15 row_mask:0xf bank_mask:0xf
    v_and_b32_dpp v47, v25, v7 row_newbcast:15 row_mask:0xf bank_mask:0xf
    s_waitcnt vmcnt(3)
    v_mfma_f32_16x16x32_bf16 v[20:23], v[32:35], v[80:83], v[20:23]
    s_waitcnt vmcnt(2)
    v_mfma_f32_16x16x32_bf16 v[20:23], v[36:39], v[84:87], v[20:23]
    s_waitcnt vmcnt(1)
    v_mfma_f32_16x16x32_bf16 v[20:23], v[40:43], v[88:91], v[20:23]
    s_waitcnt vmcnt(0)
    v_mfma_f32_16x16x32_bf16 v[20:23], v[44:47], v[92:95], v[20:23]
    v_and_b32 v11, 15, v1
    v_lshlrev_b32 v11, 5, v11
    v_lshrrev_b32 v12, 4, v1
    v_lshl_add_u32 v11, v12, 4, v11
    s_lshl_b32 s55, s3, 9
    v_add_u32 v11, s55, v11
    s_mov_b32 exec_hi, 0
    s_nop 2
    ds_write_b128 v11, v[20:23] offset:4096
    s_waitcnt lgkmcnt(0)
    s_barrier
    s_endpgm
L_helper:
    s_setprio 3
    s_sub_u32 s44, s3, 4
    v_lshrrev_b32 v2, 4, v1
    v_and_b32 v3, 15, v1
    v_lshlrev_b32 v40, 4, v1
    s_lshl_b32 s56, s42, 2
    v_add_u32 v41, s56, v3
    v_add_u32 v42, 16, v41
    v_and_b32 v41, 31, v41
    v_and_b32 v42, 31, v42
    v_lshlrev_b32 v41, 3, v41
    v_lshlrev_b32 v42, 3, v42
    v_lshl_add_u32 v41, v2, 1, v41
    v_lshl_add_u32 v42, v2, 1, v42
    s_lshl_b32 s45, s56, 15
    v_lshlrev_b32 v48, 4, v3
    v_lshl_add_u32 v48, v2, 13, v48
    v_lshlrev_b32 v49, 5, v3
    v_lshl_add_u32 v49, v2, 4, v49
    s_lshl_b32 s46, s42, 10
    s_lshl_b32 s47, s44, 8
    s_lshl_b32 s57, s44, 20
    s_lshl_b32 s56, s43, 8
    s_add_u32 s57, s57, s56
    s_waitcnt lgkmcnt(0)
    s_add_u32 s48, s16, s46
    s_addc_u32 s49, s17, 0
    s_mov_b32 s50, 1024
    s_mov_b32 s51, 0x20000
    s_add_u32 s52, s22, s57
    s_addc_u32 s53, s23, 0
    s_sub_u32 s54, 0x100000, s56
    s_mov_b32 s55, 0x20000
    buffer_load_dwordx4 v[8:11], v40, s[48:51], 0 offen
    buffer_load_ushort v12, v41, s[48:51], s47 offen
    buffer_load_ushort v13, v42, s[48:51], s47 offen
    buffer_load_dwordx4 v[64:67], v48, s[52:55], s45 offen
    s_add_u32 s45, s45, 32768
    s_and_b32 s45, s45, 0xfffff
    buffer_load_dwordx4 v[68:71], v48, s[52:55], s45 offen
    s_add_u32 s45, s45, 32768
    s_and_b32 s45, s45, 0xfffff
    buffer_load_dwordx4 v[72:75], v48, s[52:55], s45 offen
    s_add_u32 s45, s45, 32768
    s_and_b32 s45, s45, 0xfffff
    buffer_load_dwordx4 v[76:79], v48, s[52:55], s45 offen
    s_add_u32 s45, s45, 32768
    s_and_b32 s45, s45, 0xfffff
    buffer_load_dwordx4 v[80:83], v48, s[52:55], s45 offen
    s_add_u32 s45, s45, 32768
    s_and_b32 s45, s45, 0xfffff
    s_lshl_b32 s56, s43, 5
    s_lshl_b32 s57, s44, 3
    s_add_u32 s56, s56, s57
    s_add_u32 s58, s48, s56
    s_addc_u32 s59, s49, 0
    s_load_dword s78, s[34:35], 0
    s_waitcnt vmcnt(7)
    v_lshlrev_b32 v16, 16, v8
    v_and_b32 v17, 0xffff0000, v8
    v_lshlrev_b32 v18, 16, v9
    v_and_b32 v19, 0xffff0000, v9
    v_lshlrev_b32 v20, 16, v10
    v_and_b32 v21, 0xffff0000, v10
    v_lshlrev_b32 v22, 16, v11
    v_and_b32 v23, 0xffff0000, v11
    v_add_f32 v40, v16, v17
    v_add_f32 v41, v18, v19
    v_add_f32 v42, v20, v21
    v_add_f32 v40, v40, v41
    v_add_f32 v41, v22, v23
    v_add_f32 v41, v41, v42
    v_add_f32 v40, v40, v41
    s_nop 1
    v_add_f32_dpp v40, v40, v40 row_ror:8 row_mask:0xf bank_mask:0xf
    s_nop 1
    v_add_f32_dpp v40, v40, v40 row_ror:4 row_mask:0xf bank_mask:0xf
    s_nop 1
    v_add_f32_dpp v40, v40, v40 row_ror:2 row_mask:0xf bank_mask:0xf
    s_nop 1
    v_add_f32_dpp v40, v40, v40 row_ror:1 row_mask:0xf bank_mask:0xf
    s_nop 0
    v_readlane_b32 s60, v40, 0
    v_readlane_b32 s61, v40, 16
    v_readlane_b32 s62, v40, 32
    v_readlane_b32 s63, v40, 48
    s_nop 0
    v_mov_b32 v24, s60
    v_add_f32 v24, s61, v24
    v_add_f32 v24, s62, v24
    v_add_f32 v24, s63, v24
    v_mul_f32 v24, 0x3b000000, v24
    v_sub_f32 v41, v16, v24
    v_mul_f32 v40, v41, v41
    v_sub_f32 v41, v17, v24
    v_fma_f32 v40, v41, v41, v40
    v_sub_f32 v41, v18, v24
    v_fma_f32 v40, v41, v41, v40
    v_sub_f32 v41, v19, v24
    v_fma_f32 v40, v41, v41, v40
    v_sub_f32 v41, v20, v24
    v_fma_f32 v40, v41, v41, v40
    v_sub_f32 v41, v21, v24
    v_fma_f32 v40, v41, v41, v40
    v_sub_f32 v41, v22, v24
    v_fma_f32 v40, v41, v41, v40
    v_sub_f32 v41, v23, v24
    v_fma_f32 v40, v41, v41, v40
    s_nop 1
    v_add_f32_dpp v40, v40, v40 row_ror:8 row_mask:0xf bank_mask:0xf
    s_nop 1
    v_add_f32_dpp v40, v40, v40 row_ror:4 row_mask:0xf bank_mask:0xf
    s_nop 1
    v_add_f32_dpp v40, v40, v40 row_ror:2 row_mask:0xf bank_mask:0xf
    s_nop 1
    v_add_f32_dpp v40, v40, v40 row_ror:1 row_mask:0xf bank_mask:0xf
    s_nop 0
    v_readlane_b32 s60, v40, 0
    v_readlane_b32 s61, v40, 16
    v_readlane_b32 s62, v40, 32
    v_readlane_b32 s63, v40, 48
    s_nop 0
    v_mov_b32 v26, s60
    v_add_f32 v26, s61, v26
    v_add_f32 v26, s62, v26
    v_add_f32 v26, s63, v26
    v_mul_f32 v26, 0x3b000000, v26
    v_cvt_pk_bf16_f32 v25, v24, v24
    v_and_b32 v25, 0xffff0000, v25
    v_cvt_pk_bf16_f32 v26, v26, v26
    v_and_b32 v26, 0xffff0000, v26
    v_add_f32 v26, 0x3727c5ac, v26
    v_cvt_pk_bf16_f32 v26, v26, v26
    v_and_b32 v26, 0xffff0000, v26
    v_sqrt_f32 v26, v26
    s_nop 0
    v_cvt_pk_bf16_f32 v26, v26, v26
    v_and_b32 v26, 0xffff0000, v26
    v_rcp_f32 v27, v26
    s_nop 0
    s_waitcnt vmcnt(5)
    v_lshlrev_b32 v12, 16, v12
    v_sub_f32 v12, v12, v25
    v_cvt_pk_bf16_f32 v12, v12, v12
    v_and_b32 v12, 0xffff0000, v12
    v_mul_f32 v40, v12, v27
    v_fma_f32 v12, -v40, v26, v12
    v_fma_f32 v12, v12, v27, v40
    v_cvt_pk_bf16_f32 v12, v12, v12
    v_lshlrev_b32 v13, 16, v13
    v_sub_f32 v13, v13, v25
    v_cvt_pk_bf16_f32 v13, v13, v13
    v_and_b32 v13, 0xffff0000, v13
    v_mul_f32 v40, v13, v27
    v_fma_f32 v13, -v40, v26, v13
    v_fma_f32 v13, v13, v27, v40
    v_cvt_pk_bf16_f32 v13, v13, v13
    s_nop 1
    v_and_b32_dpp v28, v12, v4 row_newbcast:0 row_mask:0xf bank_mask:0xf
    v_and_b32_dpp v29, v12, v5 row_newbcast:0 row_mask:0xf bank_mask:0xf
    v_and_b32_dpp v30, v12, v6 row_newbcast:0 row_mask:0xf bank_mask:0xf
    v_and_b32_dpp v31, v12, v7 row_newbcast:0 row_mask:0xf bank_mask:0xf
    v_and_b32_dpp v32, v12, v4 row_newbcast:1 row_mask:0xf bank_mask:0xf
    v_and_b32_dpp v33, v12, v5 row_newbcast:1 row_mask:0xf bank_mask:0xf
    v_and_b32_dpp v34, v12, v6 row_newbcast:1 row_mask:0xf bank_mask:0xf
    v_and_b32_dpp v35, v12, v7 row_newbcast:1 row_mask:0xf bank_mask:0xf
    s_waitcnt vmcnt(4)
    buffer_load_dwordx4 v[84:87], v48, s[52:55], s45 offen
    s_add_u32 s45, s45, 32768
    s_and_b32 s45, s45, 0xfffff
    v_mfma_f32_16x16x32_bf16 v[36:39], v[28:31], v[64:67], 0
    v_and_b32_dpp v28, v12, v4 row_newbcast:2 row_mask:0xf bank_mask:0xf
    v_and_b32_dpp v29, v12, v5 row_newbcast:2 row_mask:0xf bank_mask:0xf
    v_and_b32_dpp v30, v12, v6 row_newbcast:2 row_mask:0xf bank_mask:0xf
    v_and_b32_dpp v31, v12, v7 row_newbcast:2 row_mask:0xf bank_mask:0xf
    s_waitcnt vmcnt(4)
    buffer_load_dwordx4 v[88:91], v48, s[52:55], s45 offen
    s_add_u32 s45, s45, 32768
    s_and_b32 s45, s45, 0xfffff
    v_mfma_f32_16x16x32_bf16 v[36:39], v[32:35], v[68:71], v[36:39]
    v_and_b32_dpp v32, v12, v4 row_newbcast:3 row_mask:0xf bank_mask:0xf
    v_and_b32_dpp v33, v12, v5 row_newbcast:3 row_mask:0xf bank_mask:0xf
    v_and_b32_dpp v34, v12, v6 row_newbcast:3 row_mask:0xf bank_mask:0xf
    v_and_b32_dpp v35, v12, v7 row_newbcast:3 row_mask:0xf bank_mask:0xf
    s_waitcnt vmcnt(4)
    buffer_load_dwordx4 v[92:95], v48, s[52:55], s45 offen
    s_add_u32 s45, s45, 32768
    s_and_b32 s45, s45, 0xfffff
    v_mfma_f32_16x16x32_bf16 v[36:39], v[28:31], v[72:75], v[36:39]
    v_and_b32_dpp v28, v12, v4 row_newbcast:4 row_mask:0xf bank_mask:0xf
    v_and_b32_dpp v29, v12, v5 row_newbcast:4 row_mask:0xf bank_mask:0xf
    v_and_b32_dpp v30, v12, v6 row_newbcast:4 row_mask:0xf bank_mask:0xf
    v_and_b32_dpp v31, v12, v7 row_newbcast:4 row_mask:0xf bank_mask:0xf
    s_waitcnt vmcnt(4)
    buffer_load_dwordx4 v[96:99], v48, s[52:55], s45 offen
    s_add_u32 s45, s45, 32768
    s_and_b32 s45, s45, 0xfffff
    v_mfma_f32_16x16x32_bf16 v[36:39], v[32:35], v[76:79], v[36:39]
    v_and_b32_dpp v32, v12, v4 row_newbcast:5 row_mask:0xf bank_mask:0xf
    v_and_b32_dpp v33, v12, v5 row_newbcast:5 row_mask:0xf bank_mask:0xf
    v_and_b32_dpp v34, v12, v6 row_newbcast:5 row_mask:0xf bank_mask:0xf
    v_and_b32_dpp v35, v12, v7 row_newbcast:5 row_mask:0xf bank_mask:0xf
    s_waitcnt vmcnt(4)
    buffer_load_dwordx4 v[100:103], v48, s[52:55], s45 offen
    s_add_u32 s45, s45, 32768
    s_and_b32 s45, s45, 0xfffff
    v_mfma_f32_16x16x32_bf16 v[36:39], v[28:31], v[80:83], v[36:39]
    v_and_b32_dpp v28, v12, v4 row_newbcast:6 row_mask:0xf bank_mask:0xf
    v_and_b32_dpp v29, v12, v5 row_newbcast:6 row_mask:0xf bank_mask:0xf
    v_and_b32_dpp v30, v12, v6 row_newbcast:6 row_mask:0xf bank_mask:0xf
    v_and_b32_dpp v31, v12, v7 row_newbcast:6 row_mask:0xf bank_mask:0xf
    s_waitcnt vmcnt(4)
    buffer_load_dwordx4 v[104:107], v48, s[52:55], s45 offen
    s_add_u32 s45, s45, 32768
    s_and_b32 s45, s45, 0xfffff
    v_mfma_f32_16x16x32_bf16 v[36:39], v[32:35], v[84:87], v[36:39]
    v_and_b32_dpp v32, v12, v4 row_newbcast:7 row_mask:0xf bank_mask:0xf
    v_and_b32_dpp v33, v12, v5 row_newbcast:7 row_mask:0xf bank_mask:0xf
    v_and_b32_dpp v34, v12, v6 row_newbcast:7 row_mask:0xf bank_mask:0xf
    v_and_b32_dpp v35, v12, v7 row_newbcast:7 row_mask:0xf bank_mask:0xf
    s_waitcnt vmcnt(4)
    buffer_load_dwordx4 v[108:111], v48, s[52:55], s45 offen
    s_add_u32 s45, s45, 32768
    s_and_b32 s45, s45, 0xfffff
    v_mfma_f32_16x16x32_bf16 v[36:39], v[28:31], v[88:91], v[36:39]
    v_and_b32_dpp v28, v12, v4 row_newbcast:8 row_mask:0xf bank_mask:0xf
    v_and_b32_dpp v29, v12, v5 row_newbcast:8 row_mask:0xf bank_mask:0xf
    v_and_b32_dpp v30, v12, v6 row_newbcast:8 row_mask:0xf bank_mask:0xf
    v_and_b32_dpp v31, v12, v7 row_newbcast:8 row_mask:0xf bank_mask:0xf
    s_waitcnt vmcnt(4)
    buffer_load_dwordx4 v[112:115], v48, s[52:55], s45 offen
    s_add_u32 s45, s45, 32768
    s_and_b32 s45, s45, 0xfffff
    v_mfma_f32_16x16x32_bf16 v[36:39], v[32:35], v[92:95], v[36:39]
    v_and_b32_dpp v32, v12, v4 row_newbcast:9 row_mask:0xf bank_mask:0xf
    v_and_b32_dpp v33, v12, v5 row_newbcast:9 row_mask:0xf bank_mask:0xf
    v_and_b32_dpp v34, v12, v6 row_newbcast:9 row_mask:0xf bank_mask:0xf
    v_and_b32_dpp v35, v12, v7 row_newbcast:9 row_mask:0xf bank_mask:0xf
    s_waitcnt vmcnt(4)
    buffer_load_dwordx4 v[116:119], v48, s[52:55], s45 offen
    s_add_u32 s45, s45, 32768
    s_and_b32 s45, s45, 0xfffff
    v_mfma_f32_16x16x32_bf16 v[36:39], v[28:31], v[96:99], v[36:39]
    v_and_b32_dpp v28, v12, v4 row_newbcast:10 row_mask:0xf bank_mask:0xf
    v_and_b32_dpp v29, v12, v5 row_newbcast:10 row_mask:0xf bank_mask:0xf
    v_and_b32_dpp v30, v12, v6 row_newbcast:10 row_mask:0xf bank_mask:0xf
    v_and_b32_dpp v31, v12, v7 row_newbcast:10 row_mask:0xf bank_mask:0xf
    s_waitcnt vmcnt(4)
    buffer_load_dwordx4 v[120:123], v48, s[52:55], s45 offen
    s_add_u32 s45, s45, 32768
    s_and_b32 s45, s45, 0xfffff
    v_mfma_f32_16x16x32_bf16 v[36:39], v[32:35], v[100:103], v[36:39]
    v_and_b32_dpp v32, v12, v4 row_newbcast:11 row_mask:0xf bank_mask:0xf
    v_and_b32_dpp v33, v12, v5 row_newbcast:11 row_mask:0xf bank_mask:0xf
    v_and_b32_dpp v34, v12, v6 row_newbcast:11 row_mask:0xf bank_mask:0xf
    v_and_b32_dpp v35, v12, v7 row_newbcast:11 row_mask:0xf bank_mask:0xf
    s_waitcnt vmcnt(4)
    buffer_load_dwordx4 v[124:127], v48, s[52:55], s45 offen
    s_add_u32 s45, s45, 32768
    s_and_b32 s45, s45, 0xfffff
    v_mfma_f32_16x16x32_bf16 v[36:39], v[28:31], v[104:107], v[36:39]
    v_and_b32_dpp v28, v12, v4 row_newbcast:12 row_mask:0xf bank_mask:0xf
    v_and_b32_dpp v29, v12, v5 row_newbcast:12 row_mask:0xf bank_mask:0xf
    v_and_b32_dpp v30, v12, v6 row_newbcast:12 row_mask:0xf bank_mask:0xf
    v_and_b32_dpp v31, v12, v7 row_newbcast:12 row_mask:0xf bank_mask:0xf
    s_waitcnt vmcnt(4)
    buffer_load_dwordx4 v[128:131], v48, s[52:55], s45 offen
    s_add_u32 s45, s45, 32768
    s_and_b32 s45, s45, 0xfffff
    v_mfma_f32_16x16x32_bf16 v[36:39], v[32:35], v[108:111], v[36:39]
    v_and_b32_dpp v32, v12, v4 row_newbcast:13 row_mask:0xf bank_mask:0xf
    v_and_b32_dpp v33, v12, v5 row_newbcast:13 row_mask:0xf bank_mask:0xf
    v_and_b32_dpp v34, v12, v6 row_newbcast:13 row_mask:0xf bank_mask:0xf
    v_and_b32_dpp v35, v12, v7 row_newbcast:13 row_mask:0xf bank_mask:0xf
    s_waitcnt vmcnt(4)
    buffer_load_dwordx4 v[132:135], v48, s[52:55], s45 offen
    s_add_u32 s45, s45, 32768
    s_and_b32 s45, s45, 0xfffff
    v_mfma_f32_16x16x32_bf16 v[36:39], v[28:31], v[112:115], v[36:39]
    v_and_b32_dpp v28, v12, v4 row_newbcast:14 row_mask:0xf bank_mask:0xf
    v_and_b32_dpp v29, v12, v5 row_newbcast:14 row_mask:0xf bank_mask:0xf
    v_and_b32_dpp v30, v12, v6 row_newbcast:14 row_mask:0xf bank_mask:0xf
    v_and_b32_dpp v31, v12, v7 row_newbcast:14 row_mask:0xf bank_mask:0xf
    s_waitcnt vmcnt(4)
    buffer_load_dwordx4 v[136:139], v48, s[52:55], s45 offen
    s_add_u32 s45, s45, 32768
    s_and_b32 s45, s45, 0xfffff
    v_mfma_f32_16x16x32_bf16 v[36:39], v[32:35], v[116:119], v[36:39]
    v_and_b32_dpp v32, v12, v4 row_newbcast:15 row_mask:0xf bank_mask:0xf
    v_and_b32_dpp v33, v12, v5 row_newbcast:15 row_mask:0xf bank_mask:0xf
    v_and_b32_dpp v34, v12, v6 row_newbcast:15 row_mask:0xf bank_mask:0xf
    v_and_b32_dpp v35, v12, v7 row_newbcast:15 row_mask:0xf bank_mask:0xf
    s_waitcnt vmcnt(4)
    buffer_load_dwordx4 v[140:143], v48, s[52:55], s45 offen
    s_add_u32 s45, s45, 32768
    s_and_b32 s45, s45, 0xfffff
    v_mfma_f32_16x16x32_bf16 v[36:39], v[28:31], v[120:123], v[36:39]
    v_and_b32_dpp v28, v13, v4 row_newbcast:0 row_mask:0xf bank_mask:0xf
    v_and_b32_dpp v29, v13, v5 row_newbcast:0 row_mask:0xf bank_mask:0xf
    v_and_b32_dpp v30, v13, v6 row_newbcast:0 row_mask:0xf bank_mask:0xf
    v_and_b32_dpp v31, v13, v7 row_newbcast:0 row_mask:0xf bank_mask:0xf
    s_waitcnt vmcnt(4)
    buffer_load_dwordx4 v[144:147], v48, s[52:55], s45 offen
    s_add_u32 s45, s45, 32768
    s_and_b32 s45, s45, 0xfffff
    v_mfma_f32_16x16x32_bf16 v[36:39], v[32:35], v[124:127], v[36:39]
    v_and_b32_dpp v32, v13, v4 row_newbcast:1 row_mask:0xf bank_mask:0xf
    v_and_b32_dpp v33, v13, v5 row_newbcast:1 row_mask:0xf bank_mask:0xf
    v_and_b32_dpp v34, v13, v6 row_newbcast:1 row_mask:0xf bank_mask:0xf
    v_and_b32_dpp v35, v13, v7 row_newbcast:1 row_mask:0xf bank_mask:0xf
    s_waitcnt vmcnt(4)
    buffer_load_dwordx4 v[148:151], v48, s[52:55], s45 offen
    s_add_u32 s45, s45, 32768
    s_and_b32 s45, s45, 0xfffff
    v_mfma_f32_16x16x32_bf16 v[36:39], v[28:31], v[128:131], v[36:39]
    v_and_b32_dpp v28, v13, v4 row_newbcast:2 row_mask:0xf bank_mask:0xf
    v_and_b32_dpp v29, v13, v5 row_newbcast:2 row_mask:0xf bank_mask:0xf
    v_and_b32_dpp v30, v13, v6 row_newbcast:2 row_mask:0xf bank_mask:0xf
    v_and_b32_dpp v31, v13, v7 row_newbcast:2 row_mask:0xf bank_mask:0xf
    s_waitcnt vmcnt(4)
    buffer_load_dwordx4 v[152:155], v48, s[52:55], s45 offen
    s_add_u32 s45, s45, 32768
    s_and_b32 s45, s45, 0xfffff
    v_mfma_f32_16x16x32_bf16 v[36:39], v[32:35], v[132:135], v[36:39]
    v_and_b32_dpp v32, v13, v4 row_newbcast:3 row_mask:0xf bank_mask:0xf
    v_and_b32_dpp v33, v13, v5 row_newbcast:3 row_mask:0xf bank_mask:0xf
    v_and_b32_dpp v34, v13, v6 row_newbcast:3 row_mask:0xf bank_mask:0xf
    v_and_b32_dpp v35, v13, v7 row_newbcast:3 row_mask:0xf bank_mask:0xf
    s_waitcnt vmcnt(4)
    buffer_load_dwordx4 v[156:159], v48, s[52:55], s45 offen
    s_add_u32 s45, s45, 32768
    s_and_b32 s45, s45, 0xfffff
    v_mfma_f32_16x16x32_bf16 v[36:39], v[28:31], v[136:139], v[36:39]
    v_and_b32_dpp v28, v13, v4 row_newbcast:4 row_mask:0xf bank_mask:0xf
    v_and_b32_dpp v29, v13, v5 row_newbcast:4 row_mask:0xf bank_mask:0xf
    v_and_b32_dpp v30, v13, v6 row_newbcast:4 row_mask:0xf bank_mask:0xf
    v_and_b32_dpp v31, v13, v7 row_newbcast:4 row_mask:0xf bank_mask:0xf
    s_waitcnt vmcnt(4)
    buffer_load_dwordx4 v[160:163], v48, s[52:55], s45 offen
    s_add_u32 s45, s45, 32768
    s_and_b32 s45, s45, 0xfffff
    v_mfma_f32_16x16x32_bf16 v[36:39], v[32:35], v[140:143], v[36:39]
    v_and_b32_dpp v32, v13, v4 row_newbcast:5 row_mask:0xf bank_mask:0xf
    v_and_b32_dpp v33, v13, v5 row_newbcast:5 row_mask:0xf bank_mask:0xf
    v_and_b32_dpp v34, v13, v6 row_newbcast:5 row_mask:0xf bank_mask:0xf
    v_and_b32_dpp v35, v13, v7 row_newbcast:5 row_mask:0xf bank_mask:0xf
    s_waitcnt vmcnt(4)
    buffer_load_dwordx4 v[164:167], v48, s[52:55], s45 offen
    s_add_u32 s45, s45, 32768
    s_and_b32 s45, s45, 0xfffff
    v_mfma_f32_16x16x32_bf16 v[36:39], v[28:31], v[144:147], v[36:39]
    v_and_b32_dpp v28, v13, v4 row_newbcast:6 row_mask:0xf bank_mask:0xf
    v_and_b32_dpp v29, v13, v5 row_newbcast:6 row_mask:0xf bank_mask:0xf
    v_and_b32_dpp v30, v13, v6 row_newbcast:6 row_mask:0xf bank_mask:0xf
    v_and_b32_dpp v31, v13, v7 row_newbcast:6 row_mask:0xf bank_mask:0xf
    s_waitcnt vmcnt(4)
    buffer_load_dwordx4 v[168:171], v48, s[52:55], s45 offen
    s_add_u32 s45, s45, 32768
    s_and_b32 s45, s45, 0xfffff
    v_mfma_f32_16x16x32_bf16 v[36:39], v[32:35], v[148:151], v[36:39]
    v_and_b32_dpp v32, v13, v4 row_newbcast:7 row_mask:0xf bank_mask:0xf
    v_and_b32_dpp v33, v13, v5 row_newbcast:7 row_mask:0xf bank_mask:0xf
    v_and_b32_dpp v34, v13, v6 row_newbcast:7 row_mask:0xf bank_mask:0xf
    v_and_b32_dpp v35, v13, v7 row_newbcast:7 row_mask:0xf bank_mask:0xf
    s_waitcnt vmcnt(4)
    buffer_load_dwordx4 v[172:175], v48, s[52:55], s45 offen
    s_add_u32 s45, s45, 32768
    s_and_b32 s45, s45, 0xfffff
    v_mfma_f32_16x16x32_bf16 v[36:39], v[28:31], v[152:155], v[36:39]
    v_and_b32_dpp v28, v13, v4 row_newbcast:8 row_mask:0xf bank_mask:0xf
    v_and_b32_dpp v29, v13, v5 row_newbcast:8 row_mask:0xf bank_mask:0xf
    v_and_b32_dpp v30, v13, v6 row_newbcast:8 row_mask:0xf bank_mask:0xf
    v_and_b32_dpp v31, v13, v7 row_newbcast:8 row_mask:0xf bank_mask:0xf
    s_waitcnt vmcnt(4)
    buffer_load_dwordx4 v[176:179], v48, s[52:55], s45 offen
    s_add_u32 s45, s45, 32768
    s_and_b32 s45, s45, 0xfffff
    v_mfma_f32_16x16x32_bf16 v[36:39], v[32:35], v[156:159], v[36:39]
    v_and_b32_dpp v32, v13, v4 row_newbcast:9 row_mask:0xf bank_mask:0xf
    v_and_b32_dpp v33, v13, v5 row_newbcast:9 row_mask:0xf bank_mask:0xf
    v_and_b32_dpp v34, v13, v6 row_newbcast:9 row_mask:0xf bank_mask:0xf
    v_and_b32_dpp v35, v13, v7 row_newbcast:9 row_mask:0xf bank_mask:0xf
    s_waitcnt vmcnt(4)
    buffer_load_dwordx4 v[180:183], v48, s[52:55], s45 offen
    s_add_u32 s45, s45, 32768
    s_and_b32 s45, s45, 0xfffff
    v_mfma_f32_16x16x32_bf16 v[36:39], v[28:31], v[160:163], v[36:39]
    v_and_b32_dpp v28, v13, v4 row_newbcast:10 row_mask:0xf bank_mask:0xf
    v_and_b32_dpp v29, v13, v5 row_newbcast:10 row_mask:0xf bank_mask:0xf
    v_and_b32_dpp v30, v13, v6 row_newbcast:10 row_mask:0xf bank_mask:0xf
    v_and_b32_dpp v31, v13, v7 row_newbcast:10 row_mask:0xf bank_mask:0xf
    s_waitcnt vmcnt(4)
    buffer_load_dwordx4 v[184:187], v48, s[52:55], s45 offen
    s_add_u32 s45, s45, 32768
    s_and_b32 s45, s45, 0xfffff
    v_mfma_f32_16x16x32_bf16 v[36:39], v[32:35], v[164:167], v[36:39]
    v_and_b32_dpp v32, v13, v4 row_newbcast:11 row_mask:0xf bank_mask:0xf
    v_and_b32_dpp v33, v13, v5 row_newbcast:11 row_mask:0xf bank_mask:0xf
    v_and_b32_dpp v34, v13, v6 row_newbcast:11 row_mask:0xf bank_mask:0xf
    v_and_b32_dpp v35, v13, v7 row_newbcast:11 row_mask:0xf bank_mask:0xf
    s_waitcnt vmcnt(4)
    buffer_load_dwordx4 v[188:191], v48, s[52:55], s45 offen
    v_mfma_f32_16x16x32_bf16 v[36:39], v[28:31], v[168:171], v[36:39]
    v_and_b32_dpp v28, v13, v4 row_newbcast:12 row_mask:0xf bank_mask:0xf
    v_and_b32_dpp v29, v13, v5 row_newbcast:12 row_mask:0xf bank_mask:0xf
    v_and_b32_dpp v30, v13, v6 row_newbcast:12 row_mask:0xf bank_mask:0xf
    v_and_b32_dpp v31, v13, v7 row_newbcast:12 row_mask:0xf bank_mask:0xf
    s_waitcnt vmcnt(4)
    v_mfma_f32_16x16x32_bf16 v[36:39], v[32:35], v[172:175], v[36:39]
    v_and_b32_dpp v32, v13, v4 row_newbcast:13 row_mask:0xf bank_mask:0xf
    v_and_b32_dpp v33, v13, v5 row_newbcast:13 row_mask:0xf bank_mask:0xf
    v_and_b32_dpp v34, v13, v6 row_newbcast:13 row_mask:0xf bank_mask:0xf
    v_and_b32_dpp v35, v13, v7 row_newbcast:13 row_mask:0xf bank_mask:0xf
    s_waitcnt vmcnt(3)
    v_mfma_f32_16x16x32_bf16 v[36:39], v[28:31], v[176:179], v[36:39]
    v_and_b32_dpp v28, v13, v4 row_newbcast:14 row_mask:0xf bank_mask:0xf
    v_and_b32_dpp v29, v13, v5 row_newbcast:14 row_mask:0xf bank_mask:0xf
    v_and_b32_dpp v30, v13, v6 row_newbcast:14 row_mask:0xf bank_mask:0xf
    v_and_b32_dpp v31, v13, v7 row_newbcast:14 row_mask:0xf bank_mask:0xf
    s_waitcnt vmcnt(2)
    v_mfma_f32_16x16x32_bf16 v[36:39], v[32:35], v[180:183], v[36:39]
    v_and_b32_dpp v32, v13, v4 row_newbcast:15 row_mask:0xf bank_mask:0xf
    v_and_b32_dpp v33, v13, v5 row_newbcast:15 row_mask:0xf bank_mask:0xf
    v_and_b32_dpp v34, v13, v6 row_newbcast:15 row_mask:0xf bank_mask:0xf
    v_and_b32_dpp v35, v13, v7 row_newbcast:15 row_mask:0xf bank_mask:0xf
    s_waitcnt vmcnt(1)
    v_mfma_f32_16x16x32_bf16 v[36:39], v[28:31], v[184:187], v[36:39]
    s_nop 1
    s_waitcnt vmcnt(0)
    v_mfma_f32_16x16x32_bf16 v[36:39], v[32:35], v[188:191], v[36:39]
    s_lshl_b32 s56, s44, 9
    v_add_u32 v40, s56, v49
    s_mov_b32 exec_hi, 0
    s_nop 5
    ds_write_b128 v40, v[36:39] offset:0
    s_mov_b32 exec_hi, -1
    s_waitcnt lgkmcnt(0)
    s_barrier
    s_setprio 0
    s_mov_b32 s64, s40
    s_mov_b32 s65, s41
    s_mov_b32 s66, 3145728
    s_mov_b32 s67, 0x20000
    s_mov_b32 s68, s38
    s_mov_b32 s69, s39
    s_mov_b32 s70, 256
    s_mov_b32 s71, 0x20000
    s_mov_b32 s72, s36
    s_mov_b32 s73, s37
    s_mov_b32 s74, 8192
    s_mov_b32 s75, 0x20000
    s_lshl_b32 s79, s42, 2
    s_add_u32 s79, s79, s44
    s_lshl_b32 s79, s79, 14
    s_lshl_b32 s80, s43, 9
    s_add_u32 s80, s80, s79
    v_add_u32 v49, s80, v49
    s_getreg_b32 s4, hwreg(HW_REG_XCC_ID)
    s_and_b32 s4, s4, 15
    s_mul_i32 s4, s4, 4352
    s_add_u32 s4, s4, 2097152
    s_mov_b32 s5, 2621440
    s_lshr_b32 s56, s2, 3
    s_lshl_b32 s56, s56, 2
    v_mov_b32 v238, s56
    v_lshlrev_b32 v239, 2, v1
    v_and_b32 v240, 7, v1
    v_mul_u32_u24 v240, 4352, v240
    s_and_b32 s56, s2, 7
    s_mul_i32 s56, s56, 4352
    v_mov_b32 v241, s56
    v_mov_b32 v242, 128
    v_mov_b32 v236, 0
    v_mov_b32 v237, 0
    v_mov_b32 v244, 0
    v_mov_b32 v245, 0
    v_mov_b32 v248, 0
    v_mov_b32 v251, 0
    v_mov_b32 v249, 2320
    s_mov_b32 s7, 5
    s_mov_b32 s94, 1536
    s_cmp_lg_u32 s44, 3
    s_cbranch_scc1 L_cinit_done
    s_mov_b64 exec, 1
    buffer_store_dword v248, v238, s[64:67], s4 offen
    s_cmp_ge_u32 s2, 8
    s_cbranch_scc1 L_cinit_done
    buffer_store_dword v248, v242, s[64:67], s4 offen
L_cinit_done:
    s_mov_b64 exec, -1
    s_mov_b32 exec_hi, 0
    buffer_load_dwordx4 v[8:11], v49, s[64:67], 0 offen sc1
    s_mov_b32 exec_hi, -1
    s_lshr_b32 s83, s43, 2
    s_lshl_b32 s79, s43, 14
    s_lshl_b32 s56, s44, 7
    s_add_u32 s79, s79, s56
    s_and_b32 s81, s43, 3
    s_lshl_b32 s81, s81, 8
    s_lshl_b32 s56, s44, 6
    s_add_u32 s81, s81, s56
    v_and_b32 v42, 7, v1
    v_lshrrev_b32 v43, 3, v1
    v_lshlrev_b32 v15, 4, v42
    v_lshl_add_u32 v15, v43, 9, v15
    v_lshrrev_b32 v43, 5, v1
    v_bfe_u32 v44, v1, 4, 1
    v_lshl_add_u32 v43, v44, 1, v43
    v_lshl_add_u32 v43, v42, 2, v43
    v_lshlrev_b32 v14, 1, v43
    s_cmp_lg_u32 s83, s42
    s_cbranch_scc1 L_noold
    s_mov_b32 s56, s79
    buffer_load_dwordx4 v[64:67], v15, s[64:67], s56 offen sc1
    s_add_u32 s56, s56, 4096
    buffer_load_dwordx4 v[68:71], v15, s[64:67], s56 offen sc1
    s_add_u32 s56, s56, 4096
    buffer_load_dwordx4 v[72:75], v15, s[64:67], s56 offen sc1
    s_add_u32 s56, s56, 4096
    buffer_load_dwordx4 v[76:79], v15, s[64:67], s56 offen sc1
    buffer_load_ushort v50, v14, s[48:51], s81 offen
    s_waitcnt vmcnt(0)
    v_alignbit_b32 v53, v64, v53, 1
    v_alignbit_b32 v53, v65, v53, 1
    v_alignbit_b32 v53, v66, v53, 1
    v_alignbit_b32 v53, v67, v53, 1
    v_alignbit_b32 v53, v68, v53, 1
    v_alignbit_b32 v53, v69, v53, 1
    v_alignbit_b32 v53, v70, v53, 1
    v_alignbit_b32 v53, v71, v53, 1
    v_alignbit_b32 v53, v72, v53, 1
    v_alignbit_b32 v53, v73, v53, 1
    v_alignbit_b32 v53, v74, v53, 1
    v_alignbit_b32 v53, v75, v53, 1
    v_alignbit_b32 v53, v76, v53, 1
    v_alignbit_b32 v53, v77, v53, 1
    v_alignbit_b32 v53, v78, v53, 1
    v_alignbit_b32 v53, v79, v53, 1
    v_lshlrev_b32 v50, 16, v50
    v_mov_b32 v40, 0
    v_mov_b32 v41, 1
    s_mov_b64 exec, 1
    ds_add_rtn_u32 v42, v40, v41 offset:2336
    s_lshl_b32 s56, s43, 2
    s_waitcnt lgkmcnt(0)
    v_readfirstlane_b32 s57, v42
    s_cmp_lg_u32 s57, 3
    s_cbranch_scc1 L_noflag
    buffer_store_dword v41, v40, s[68:71], s56 offen sc1
L_noflag:
    s_mov_b64 exec, -1
L_noold:
    s_mov_b32 s52, s24
    s_mov_b32 s53, s25
    s_mov_b32 s54, 0x400000
    s_mov_b32 s55, 0x20000
    v_lshlrev_b32 v47, 4, v1
    s_lshl_b32 s56, s43, 17
    s_lshl_b32 s57, s42, 14
    s_add_u32 s56, s56, s57
    s_lshl_b32 s57, s44, 12
    s_add_u32 s56, s56, s57
    buffer_load_dwordx4 v[64:67], v47, s[52:55], s56 offen offset:0
    buffer_load_dwordx4 v[68:71], v47, s[52:55], s56 offen offset:1024
    s_waitcnt vmcnt(1)
    buffer_load_dwordx4 v[72:75], v47, s[52:55], s56 offen offset:2048
    s_waitcnt vmcnt(1)
    buffer_load_dwordx4 v[76:79], v47, s[52:55], s56 offen offset:3072
    s_waitcnt vmcnt(0)
    s_cmp_lg_u32 s44, 3
    s_cbranch_scc1 L_cskipk
    v_lshlrev_b32 v246, 3, v1
    s_mov_b64 exec, 1
    ds_read_b128 v[232:235], v248 offset:2304
    s_waitcnt lgkmcnt(0)
    v_add_u32 v232, v232, v233
    v_add3_u32 v243, v232, v234, v235
    s_nop 1
    v_readfirstlane_b32 s6, v243
L_cloopk:
    s_sleep 16
    s_mov_b64 exec, 15
    ds_read_b32 v250, v239 offset:2304
    s_mov_b64 exec, 1
    ds_read_b128 v[232:235], v248 offset:2304
    s_waitcnt lgkmcnt(0)
    v_add_u32 v232, v232, v233
    v_add3_u32 v243, v232, v234, v235
    s_nop 1
    v_readfirstlane_b32 s8, v243
    s_nop 0
    s_cmp_ge_u32 s8, 488
    s_cbranch_scc1 L_cexitk
    buffer_store_dword v243, v238, s[64:67], s4 offen
    s_mov_b32 exec_lo, -1
    s_mov_b32 exec_hi, 1
    buffer_load_dword v244, v239, s[64:67], s4 offen sc1
    s_add_u32 s7, s7, 1
    s_cmp_ge_u32 s7, 6
    s_cselect_b32 s7, 0, s7
    s_cmp_ge_u32 s2, 8
    s_cbranch_scc1 L_cn1k
    s_mov_b64 exec, 0xff
    buffer_load_dword v245, v240, s[64:67], s5 offen sc1
L_cn1k:
    s_mov_b64 exec, -1
    s_sub_i32 s56, s8, 64
    s_add_i32 s57, s8, 64
    v_mov_b32 v246, s57
    v_lshlrev_b32 v250, 2, v250
    v_subrev_u32 v250, s8, v250
    v_ashrrev_i32 v251, 1, v251
    v_add_u32 v251, v251, v250
    v_mul_i32_i24 v250, 12, v251
    s_waitcnt vmcnt(0)
    v_readlane_b32 s9, v244, 32
    v_med3_i32 v244, v244, s56, v246
    s_nop 1
    v_add_u32_dpp v244, v244, v244 row_ror:8 row_mask:0xf bank_mask:0xf
    s_nop 1
    v_add_u32_dpp v244, v244, v244 row_ror:4 row_mask:0xf bank_mask:0xf
    s_nop 1
    v_add_u32_dpp v244, v244, v244 row_ror:2 row_mask:0xf bank_mask:0xf
    s_nop 1
    v_add_u32_dpp v244, v244, v244 row_ror:1 row_mask:0xf bank_mask:0xf
    s_nop 0
    v_readlane_b32 s10, v244, 0
    v_readlane_b32 s56, v244, 16
    s_nop 3
    s_add_u32 s10, s10, s56
    s_cmp_ge_u32 s2, 8
    s_cbranch_scc1 L_cn2k
    v_cmp_ne_u32 vcc, v245, v236
    v_sub_u32 v246, s10, v245
    v_subrev_u32 v246, 220, v246
    v_add_u32 v247, 768, v246
    v_cmp_gt_u32 s[56:57], s94, v247
    s_and_b64 vcc, vcc, s[56:57]
    v_cndmask_b32 v237, v237, v246, vcc
    v_mov_b32 v236, v245
    v_writelane_b32 v237, 0, s2
    s_nop 0
    v_readlane_b32 s18, v237, 0
    v_readlane_b32 s19, v237, 1
    v_readlane_b32 s20, v237, 2
    v_readlane_b32 s21, v237, 3
    v_readlane_b32 s22, v237, 4
    v_readlane_b32 s23, v237, 5
    v_readlane_b32 s26, v237, 6
    v_readlane_b32 s27, v237, 7
    s_nop 3
    s_add_u32 s18, s18, s19
    s_add_u32 s18, s18, s20
    s_add_u32 s18, s18, s21
    s_add_u32 s18, s18, s22
    s_add_u32 s18, s18, s23
    s_add_u32 s18, s18, s26
    s_add_u32 s18, s18, s27
    s_ashr_i32 s9, s18, 3
    s_mov_b64 exec, 1
    v_mov_b32 v246, s10
    v_mov_b32 v247, s9
    buffer_store_dword v247, v242, s[64:67], s4 offen
    s_cmp_lg_u32 s7, 0
    s_cbranch_scc1 L_cn2k
    buffer_store_dword v246, v241, s[64:67], s5 offen sc1
L_cn2k:
    s_add_u32 s11, s8, s6
    s_lshl_b32 s11, s11, 4
    s_sub_i32 s11, s11, s10
    s_add_i32 s11, s11, s9
    s_mov_b32 s6, s8
    s_mov_b32 s12, 1
    s_cmp_gt_i32 s11, 24
    s_cselect_b32 s12, 2, s12
    s_cmp_lt_i32 s11, -72
    s_cselect_b32 s12, 0, s12
    s_mov_b64 exec, 15
    v_add_u32 v250, s11, v250
    v_cmp_lt_i32 vcc, 24, v250
    v_mov_b32 v246, 1
    s_nop 0
    v_cndmask_b32 v246, v246, 2, vcc
    v_cmp_gt_i32 vcc, -72, v250
    s_nop 1
    v_cndmask_b32 v246, v246, 0, vcc
    ds_write_b32 v239, v246 offset:2320
    s_branch L_cloopk
L_cexitk:
    v_add_u32 v243, 12, v243
    buffer_store_dword v243, v238, s[64:67], s4 offen
    s_mov_b64 exec, 0xff
    v_lshlrev_b32 v246, 3, v1
    ds_write_b64 v246, v[236:237] offset:2560
    s_mov_b64 exec, -1
    s_waitcnt lgkmcnt(0)
    s_barrier
L_cskipk:
    s_cmp_lg_u32 s83, s42
    s_cbranch_scc1 L_nogate
    v_lshlrev_b32 v47, 3, v1
    s_mov_b32 s52, s28
    s_mov_b32 s53, s29
    s_mov_b32 s54, 3584
    s_mov_b32 s55, 0x20000
    buffer_load_dwordx2 v[192:193], v47, s[52:55], 0 offen offset:0
    buffer_load_dwordx2 v[194:195], v47, s[52:55], 0 offen offset:512
    buffer_load_dwordx2 v[196:197], v47, s[52:55], 0 offen offset:1024
    buffer_load_dwordx2 v[198:199], v47, s[52:55], 0 offen offset:1536
    buffer_load_dwordx2 v[200:201], v47, s[52:55], 0 offen offset:2048
    buffer_load_dwordx2 v[202:203], v47, s[52:55], 0 offen offset:2560
    buffer_load_dwordx2 v[204:205], v47, s[52:55], 0 offen offset:3072
    s_mov_b32 s52, s30
    s_mov_b32 s53, s31
    s_mov_b32 s54, 3584
    s_mov_b32 s55, 0x20000
    buffer_load_dwordx2 v[206:207], v47, s[52:55], 0 offen offset:0
    buffer_load_dwordx2 v[208:209], v47, s[52:55], 0 offen offset:512
    buffer_load_dwordx2 v[210:211], v47, s[52:55], 0 offen offset:1024
    buffer_load_dwordx2 v[212:213], v47, s[52:55], 0 offen offset:1536
    buffer_load_dwordx2 v[214:215], v47, s[52:55], 0 offen offset:2048
    buffer_load_dwordx2 v[216:217], v47, s[52:55], 0 offen offset:2560
    buffer_load_dwordx2 v[218:219], v47, s[52:55], 0 offen offset:3072
    s_mov_b32 s52, s32
    s_mov_b32 s53, s33
    s_mov_b32 s54, 3584
    s_mov_b32 s55, 0x20000
    buffer_load_dwordx2 v[220:221], v47, s[52:55], 0 offen offset:0
    buffer_load_dwordx2 v[222:223], v47, s[52:55], 0 offen offset:512
    buffer_load_dwordx2 v[224:225], v47, s[52:55], 0 offen offset:1024
    buffer_load_dwordx2 v[226:227], v47, s[52:55], 0 offen offset:1536
    buffer_load_dwordx2 v[228:229], v47, s[52:55], 0 offen offset:2048
    buffer_load_dwordx2 v[230:231], v47, s[52:55], 0 offen offset:2560
    buffer_load_dwordx2 v[232:233], v47, s[52:55], 0 offen offset:3072
    s_setprio 0
    v_sub_f32 v16, v16, v25
    v_cvt_pk_bf16_f32 v16, v16, v16
    v_and_b32 v16, 0xffff0000, v16
    v_mul_f32 v40, v16, v27
    v_fma_f32 v16, -v40, v26, v16
    v_fma_f32 v16, v16, v27, v40
    v_cvt_pk_bf16_f32 v16, v16, v16
    v_and_b32 v16, 0xffff0000, v16
    v_sub_f32 v17, v17, v25
    v_cvt_pk_bf16_f32 v17, v17, v17
    v_and_b32 v17, 0xffff0000, v17
    v_mul_f32 v40, v17, v27
    v_fma_f32 v17, -v40, v26, v17
    v_fma_f32 v17, v17, v27, v40
    v_cvt_pk_bf16_f32 v17, v17, v17
    v_and_b32 v17, 0xffff0000, v17
    v_sub_f32 v18, v18, v25
    v_cvt_pk_bf16_f32 v18, v18, v18
    v_and_b32 v18, 0xffff0000, v18
    v_mul_f32 v40, v18, v27
    v_fma_f32 v18, -v40, v26, v18
    v_fma_f32 v18, v18, v27, v40
    v_cvt_pk_bf16_f32 v18, v18, v18
    v_and_b32 v18, 0xffff0000, v18
    v_sub_f32 v19, v19, v25
    v_cvt_pk_bf16_f32 v19, v19, v19
    v_and_b32 v19, 0xffff0000, v19
    v_mul_f32 v40, v19, v27
    v_fma_f32 v19, -v40, v26, v19
    v_fma_f32 v19, v19, v27, v40
    v_cvt_pk_bf16_f32 v19, v19, v19
    v_and_b32 v19, 0xffff0000, v19
    v_sub_f32 v20, v20, v25
    v_cvt_pk_bf16_f32 v20, v20, v20
    v_and_b32 v20, 0xffff0000, v20
    v_mul_f32 v40, v20, v27
    v_fma_f32 v20, -v40, v26, v20
    v_fma_f32 v20, v20, v27, v40
    v_cvt_pk_bf16_f32 v20, v20, v20
    v_and_b32 v20, 0xffff0000, v20
    v_sub_f32 v21, v21, v25
    v_cvt_pk_bf16_f32 v21, v21, v21
    v_and_b32 v21, 0xffff0000, v21
    v_mul_f32 v40, v21, v27
    v_fma_f32 v21, -v40, v26, v21
    v_fma_f32 v21, v21, v27, v40
    v_cvt_pk_bf16_f32 v21, v21, v21
    v_and_b32 v21, 0xffff0000, v21
    v_sub_f32 v22, v22, v25
    v_cvt_pk_bf16_f32 v22, v22, v22
    v_and_b32 v22, 0xffff0000, v22
    v_mul_f32 v40, v22, v27
    v_fma_f32 v22, -v40, v26, v22
    v_fma_f32 v22, v22, v27, v40
    v_cvt_pk_bf16_f32 v22, v22, v22
    v_and_b32 v22, 0xffff0000, v22
    v_sub_f32 v23, v23, v25
    v_cvt_pk_bf16_f32 v23, v23, v23
    v_and_b32 v23, 0xffff0000, v23
    v_mul_f32 v40, v23, v27
    v_fma_f32 v23, -v40, v26, v23
    v_fma_f32 v23, v23, v27, v40
    v_cvt_pk_bf16_f32 v23, v23, v23
    v_and_b32 v23, 0xffff0000, v23
    v_mov_b32 v52, v50
    s_lshl_b32 s78, s78, 16
    v_sub_f32 v52, v52, v25
    v_cvt_pk_bf16_f32 v52, v52, v52
    v_and_b32 v52, 0xffff0000, v52
    v_mul_f32 v40, v52, v27
    v_fma_f32 v52, -v40, v26, v52
    v_fma_f32 v52, v52, v27, v40
    v_cvt_pk_bf16_f32 v52, v52, v52
    v_and_b32 v52, 0xffff0000, v52
    v_add_f32 v40, v16, v17
    v_add_f32 v41, v18, v19
    v_add_f32 v42, v20, v21
    v_add_f32 v40, v40, v41
    v_add_f32 v41, v22, v23
    v_add_f32 v41, v41, v42
    v_add_f32 v40, v40, v41
    s_nop 1
    v_add_f32_dpp v40, v40, v40 row_ror:8 row_mask:0xf bank_mask:0xf
    s_nop 1
    v_add_f32_dpp v40, v40, v40 row_ror:4 row_mask:0xf bank_mask:0xf
    s_nop 1
    v_add_f32_dpp v40, v40, v40 row_ror:2 row_mask:0xf bank_mask:0xf
    s_nop 1
    v_add_f32_dpp v40, v40, v40 row_ror:1 row_mask:0xf bank_mask:0xf
    s_nop 0
    v_readlane_b32 s60, v40, 0
    v_readlane_b32 s61, v40, 16
    v_readlane_b32 s62, v40, 32
    v_readlane_b32 s63, v40, 48
    s_nop 0
    v_mov_b32 v24, s60
    v_add_f32 v24, s61, v24
    v_add_f32 v24, s62, v24
    v_add_f32 v24, s63, v24
    v_mul_f32 v24, 0x3b000000, v24
    v_sub_f32 v41, v16, v24
    v_mul_f32 v40, v41, v41
    v_sub_f32 v41, v17, v24
    v_fma_f32 v40, v41, v41, v40
    v_sub_f32 v41, v18, v24
    v_fma_f32 v40, v41, v41, v40
    v_sub_f32 v41, v19, v24
    v_fma_f32 v40, v41, v41, v40
    v_sub_f32 v41, v20, v24
    v_fma_f32 v40, v41, v41, v40
    v_sub_f32 v41, v21, v24
    v_fma_f32 v40, v41, v41, v40
    v_sub_f32 v41, v22, v24
    v_fma_f32 v40, v41, v41, v40
    v_sub_f32 v41, v23, v24
    v_fma_f32 v40, v41, v41, v40
    s_nop 1
    v_add_f32_dpp v40, v40, v40 row_ror:8 row_mask:0xf bank_mask:0xf
    s_nop 1
    v_add_f32_dpp v40, v40, v40 row_ror:4 row_mask:0xf bank_mask:0xf
    s_nop 1
    v_add_f32_dpp v40, v40, v40 row_ror:2 row_mask:0xf bank_mask:0xf
    s_nop 1
    v_add_f32_dpp v40, v40, v40 row_ror:1 row_mask:0xf bank_mask:0xf
    s_nop 0
    v_readlane_b32 s60, v40, 0
    v_readlane_b32 s61, v40, 16
    v_readlane_b32 s62, v40, 32
    v_readlane_b32 s63, v40, 48
    s_nop 0
    v_mov_b32 v26, s60
    v_add_f32 v26, s61, v26
    v_add_f32 v26, s62, v26
    v_add_f32 v26, s63, v26
    v_mul_f32 v26, 0x3b000000, v26
    v_cvt_pk_bf16_f32 v25, v24, v24
    v_and_b32 v25, 0xffff0000, v25
    v_cvt_pk_bf16_f32 v26, v26, v26
    v_and_b32 v26, 0xffff0000, v26
    v_add_f32 v26, 0x3727c5ac, v26
    v_cvt_pk_bf16_f32 v26, v26, v26
    v_and_b32 v26, 0xffff0000, v26
    v_sqrt_f32 v26, v26
    s_nop 0
    v_cvt_pk_bf16_f32 v26, v26, v26
    v_and_b32 v26, 0xffff0000, v26
    v_rcp_f32 v27, v26
    s_nop 0
    v_sub_f32 v52, v52, v25
    v_cvt_pk_bf16_f32 v52, v52, v52
    v_and_b32 v52, 0xffff0000, v52
    v_mul_f32 v40, v52, v27
    v_fma_f32 v52, -v40, v26, v52
    v_fma_f32 v52, v52, v27, v40
    v_cvt_pk_bf16_f32 v52, v52, v52
    v_and_b32 v52, 0xffff0000, v52
    v_mov_b32 v57, 0xc0135761
    v_mov_b32 v58, 0xbdd2d3e8
    v_mov_b32 v56, 0
    s_waitcnt vmcnt(0)
    v_lshlrev_b32 v64, 16, v192
    v_and_b32 v65, 0xffff0000, v192
    v_lshlrev_b32 v66, 16, v193
    v_and_b32 v67, 0xffff0000, v193
    v_lshlrev_b32 v68, 16, v194
    v_and_b32 v69, 0xffff0000, v194
    v_lshlrev_b32 v70, 16, v195
    v_and_b32 v71, 0xffff0000, v195
    v_lshlrev_b32 v72, 16, v196
    v_and_b32 v73, 0xffff0000, v196
    v_lshlrev_b32 v74, 16, v197
    v_and_b32 v75, 0xffff0000, v197
    v_lshlrev_b32 v76, 16, v198
    v_and_b32 v77, 0xffff0000, v198
    v_lshlrev_b32 v78, 16, v199
    v_and_b32 v79, 0xffff0000, v199
    v_lshlrev_b32 v80, 16, v200
    v_and_b32 v81, 0xffff0000, v200
    v_lshlrev_b32 v82, 16, v201
    v_and_b32 v83, 0xffff0000, v201
    v_lshlrev_b32 v84, 16, v202
    v_and_b32 v85, 0xffff0000, v202
    v_lshlrev_b32 v86, 16, v203
    v_and_b32 v87, 0xffff0000, v203
    v_lshlrev_b32 v88, 16, v204
    v_and_b32 v89, 0xffff0000, v204
    v_lshlrev_b32 v90, 16, v205
    v_and_b32 v91, 0xffff0000, v205
    v_lshlrev_b32 v92, 16, v206
    v_and_b32 v93, 0xffff0000, v206
    v_lshlrev_b32 v94, 16, v207
    v_and_b32 v95, 0xffff0000, v207
    v_lshlrev_b32 v96, 16, v208
    v_and_b32 v97, 0xffff0000, v208
    v_lshlrev_b32 v98, 16, v209
    v_and_b32 v99, 0xffff0000, v209
    v_lshlrev_b32 v100, 16, v210
    v_and_b32 v101, 0xffff0000, v210
    v_lshlrev_b32 v102, 16, v211
    v_and_b32 v103, 0xffff0000, v211
    v_lshlrev_b32 v104, 16, v212
    v_and_b32 v105, 0xffff0000, v212
    v_lshlrev_b32 v106, 16, v213
    v_and_b32 v107, 0xffff0000, v213
    v_lshlrev_b32 v108, 16, v214
    v_and_b32 v109, 0xffff0000, v214
    v_lshlrev_b32 v110, 16, v215
    v_and_b32 v111, 0xffff0000, v215
    v_lshlrev_b32 v112, 16, v216
    v_and_b32 v113, 0xffff0000, v216
    v_lshlrev_b32 v114, 16, v217
    v_and_b32 v115, 0xffff0000, v217
    v_lshlrev_b32 v116, 16, v218
    v_and_b32 v117, 0xffff0000, v218
    v_lshlrev_b32 v118, 16, v219
    v_and_b32 v119, 0xffff0000, v219
    v_lshlrev_b32 v120, 16, v220
    v_and_b32 v121, 0xffff0000, v220
    v_lshlrev_b32 v122, 16, v221
    v_and_b32 v123, 0xffff0000, v221
    v_lshlrev_b32 v124, 16, v222
    v_and_b32 v125, 0xffff0000, v222
    v_lshlrev_b32 v126, 16, v223
    v_and_b32 v127, 0xffff0000, v223
    v_lshlrev_b32 v128, 16, v224
    v_and_b32 v129, 0xffff0000, v224
    v_lshlrev_b32 v130, 16, v225
    v_and_b32 v131, 0xffff0000, v225
    v_lshlrev_b32 v132, 16, v226
    v_and_b32 v133, 0xffff0000, v226
    v_lshlrev_b32 v134, 16, v227
    v_and_b32 v135, 0xffff0000, v227
    v_lshlrev_b32 v136, 16, v228
    v_and_b32 v137, 0xffff0000, v228
    v_lshlrev_b32 v138, 16, v229
    v_and_b32 v139, 0xffff0000, v229
    v_lshlrev_b32 v140, 16, v230
    v_and_b32 v141, 0xffff0000, v230
    v_lshlrev_b32 v142, 16, v231
    v_and_b32 v143, 0xffff0000, v231
    v_lshlrev_b32 v144, 16, v232
    v_and_b32 v145, 0xffff0000, v232
    v_lshlrev_b32 v146, 16, v233
    v_and_b32 v147, 0xffff0000, v233
    s_mov_b32 s57, 0
L_gate:
    v_readlane_b32 s58, v52, s57
    v_mov_b32 v45, 0
    s_nop 0
    v_mul_f32 v40, s58, v64
    v_mul_f32 v41, s58, v65
    v_cvt_pk_bf16_f32 v44, v40, v41
    v_lshlrev_b32 v40, 16, v44
    v_and_b32 v41, 0xffff0000, v44
    v_add_f32 v40, v40, v92
    v_add_f32 v41, v41, v93
    v_cvt_pk_bf16_f32 v44, v40, v41
    v_lshlrev_b32 v40, 16, v44
    v_and_b32 v41, 0xffff0000, v44
    v_mul_f32 v42, v40, v40
    v_mul_f32 v43, v41, v41
    v_fma_f32 v42, v42, v58, v57
    v_fma_f32 v43, v43, v58, v57
    v_mul_f32 v42, v42, v40
    v_mul_f32 v43, v43, v41
    v_exp_f32 v42, v42
    v_exp_f32 v43, v43
    v_add_f32 v42, 1.0, v42
    v_add_f32 v43, 1.0, v43
    v_rcp_f32 v42, v42
    v_rcp_f32 v43, v43
    v_mul_f32 v40, v40, v42
    v_mul_f32 v41, v41, v43
    v_cvt_pk_bf16_f32 v44, v40, v41
    v_lshlrev_b32 v40, 16, v44
    v_and_b32 v41, 0xffff0000, v44
    v_fma_f32 v45, v40, v120, v45
    v_fma_f32 v45, v41, v121, v45
    v_mul_f32 v40, s58, v66
    v_mul_f32 v41, s58, v67
    v_cvt_pk_bf16_f32 v44, v40, v41
    v_lshlrev_b32 v40, 16, v44
    v_and_b32 v41, 0xffff0000, v44
    v_add_f32 v40, v40, v94
    v_add_f32 v41, v41, v95
    v_cvt_pk_bf16_f32 v44, v40, v41
    v_lshlrev_b32 v40, 16, v44
    v_and_b32 v41, 0xffff0000, v44
    v_mul_f32 v42, v40, v40
    v_mul_f32 v43, v41, v41
    v_fma_f32 v42, v42, v58, v57
    v_fma_f32 v43, v43, v58, v57
    v_mul_f32 v42, v42, v40
    v_mul_f32 v43, v43, v41
    v_exp_f32 v42, v42
    v_exp_f32 v43, v43
    v_add_f32 v42, 1.0, v42
    v_add_f32 v43, 1.0, v43
    v_rcp_f32 v42, v42
    v_rcp_f32 v43, v43
    v_mul_f32 v40, v40, v42
    v_mul_f32 v41, v41, v43
    v_cvt_pk_bf16_f32 v44, v40, v41
    v_lshlrev_b32 v40, 16, v44
    v_and_b32 v41, 0xffff0000, v44
    v_fma_f32 v45, v40, v122, v45
    v_fma_f32 v45, v41, v123, v45
    v_mul_f32 v40, s58, v68
    v_mul_f32 v41, s58, v69
    v_cvt_pk_bf16_f32 v44, v40, v41
    v_lshlrev_b32 v40, 16, v44
    v_and_b32 v41, 0xffff0000, v44
    v_add_f32 v40, v40, v96
    v_add_f32 v41, v41, v97
    v_cvt_pk_bf16_f32 v44, v40, v41
    v_lshlrev_b32 v40, 16, v44
    v_and_b32 v41, 0xffff0000, v44
    v_mul_f32 v42, v40, v40
    v_mul_f32 v43, v41, v41
    v_fma_f32 v42, v42, v58, v57
    v_fma_f32 v43, v43, v58, v57
    v_mul_f32 v42, v42, v40
    v_mul_f32 v43, v43, v41
    v_exp_f32 v42, v42
    v_exp_f32 v43, v43
    v_add_f32 v42, 1.0, v42
    v_add_f32 v43, 1.0, v43
    v_rcp_f32 v42, v42
    v_rcp_f32 v43, v43
    v_mul_f32 v40, v40, v42
    v_mul_f32 v41, v41, v43
    v_cvt_pk_bf16_f32 v44, v40, v41
    v_lshlrev_b32 v40, 16, v44
    v_and_b32 v41, 0xffff0000, v44
    v_fma_f32 v45, v40, v124, v45
    v_fma_f32 v45, v41, v125, v45
    v_mul_f32 v40, s58, v70
    v_mul_f32 v41, s58, v71
    v_cvt_pk_bf16_f32 v44, v40, v41
    v_lshlrev_b32 v40, 16, v44
    v_and_b32 v41, 0xffff0000, v44
    v_add_f32 v40, v40, v98
    v_add_f32 v41, v41, v99
    v_cvt_pk_bf16_f32 v44, v40, v41
    v_lshlrev_b32 v40, 16, v44
    v_and_b32 v41, 0xffff0000, v44
    v_mul_f32 v42, v40, v40
    v_mul_f32 v43, v41, v41
    v_fma_f32 v42, v42, v58, v57
    v_fma_f32 v43, v43, v58, v57
    v_mul_f32 v42, v42, v40
    v_mul_f32 v43, v43, v41
    v_exp_f32 v42, v42
    v_exp_f32 v43, v43
    v_add_f32 v42, 1.0, v42
    v_add_f32 v43, 1.0, v43
    v_rcp_f32 v42, v42
    v_rcp_f32 v43, v43
    v_mul_f32 v40, v40, v42
    v_mul_f32 v41, v41, v43
    v_cvt_pk_bf16_f32 v44, v40, v41
    v_lshlrev_b32 v40, 16, v44
    v_and_b32 v41, 0xffff0000, v44
    v_fma_f32 v45, v40, v126, v45
    v_fma_f32 v45, v41, v127, v45
    v_mul_f32 v40, s58, v72
    v_mul_f32 v41, s58, v73
    v_cvt_pk_bf16_f32 v44, v40, v41
    v_lshlrev_b32 v40, 16, v44
    v_and_b32 v41, 0xffff0000, v44
    v_add_f32 v40, v40, v100
    v_add_f32 v41, v41, v101
    v_cvt_pk_bf16_f32 v44, v40, v41
    v_lshlrev_b32 v40, 16, v44
    v_and_b32 v41, 0xffff0000, v44
    v_mul_f32 v42, v40, v40
    v_mul_f32 v43, v41, v41
    v_fma_f32 v42, v42, v58, v57
    v_fma_f32 v43, v43, v58, v57
    v_mul_f32 v42, v42, v40
    v_mul_f32 v43, v43, v41
    v_exp_f32 v42, v42
    v_exp_f32 v43, v43
    v_add_f32 v42, 1.0, v42
    v_add_f32 v43, 1.0, v43
    v_rcp_f32 v42, v42
    v_rcp_f32 v43, v43
    v_mul_f32 v40, v40, v42
    v_mul_f32 v41, v41, v43
    v_cvt_pk_bf16_f32 v44, v40, v41
    v_lshlrev_b32 v40, 16, v44
    v_and_b32 v41, 0xffff0000, v44
    v_fma_f32 v45, v40, v128, v45
    v_fma_f32 v45, v41, v129, v45
    v_mul_f32 v40, s58, v74
    v_mul_f32 v41, s58, v75
    v_cvt_pk_bf16_f32 v44, v40, v41
    v_lshlrev_b32 v40, 16, v44
    v_and_b32 v41, 0xffff0000, v44
    v_add_f32 v40, v40, v102
    v_add_f32 v41, v41, v103
    v_cvt_pk_bf16_f32 v44, v40, v41
    v_lshlrev_b32 v40, 16, v44
    v_and_b32 v41, 0xffff0000, v44
    v_mul_f32 v42, v40, v40
    v_mul_f32 v43, v41, v41
    v_fma_f32 v42, v42, v58, v57
    v_fma_f32 v43, v43, v58, v57
    v_mul_f32 v42, v42, v40
    v_mul_f32 v43, v43, v41
    v_exp_f32 v42, v42
    v_exp_f32 v43, v43
    v_add_f32 v42, 1.0, v42
    v_add_f32 v43, 1.0, v43
    v_rcp_f32 v42, v42
    v_rcp_f32 v43, v43
    v_mul_f32 v40, v40, v42
    v_mul_f32 v41, v41, v43
    v_cvt_pk_bf16_f32 v44, v40, v41
    v_lshlrev_b32 v40, 16, v44
    v_and_b32 v41, 0xffff0000, v44
    v_fma_f32 v45, v40, v130, v45
    v_fma_f32 v45, v41, v131, v45
    v_mul_f32 v40, s58, v76
    v_mul_f32 v41, s58, v77
    v_cvt_pk_bf16_f32 v44, v40, v41
    v_lshlrev_b32 v40, 16, v44
    v_and_b32 v41, 0xffff0000, v44
    v_add_f32 v40, v40, v104
    v_add_f32 v41, v41, v105
    v_cvt_pk_bf16_f32 v44, v40, v41
    v_lshlrev_b32 v40, 16, v44
    v_and_b32 v41, 0xffff0000, v44
    v_mul_f32 v42, v40, v40
    v_mul_f32 v43, v41, v41
    v_fma_f32 v42, v42, v58, v57
    v_fma_f32 v43, v43, v58, v57
    v_mul_f32 v42, v42, v40
    v_mul_f32 v43, v43, v41
    v_exp_f32 v42, v42
    v_exp_f32 v43, v43
    v_add_f32 v42, 1.0, v42
    v_add_f32 v43, 1.0, v43
    v_rcp_f32 v42, v42
    v_rcp_f32 v43, v43
    v_mul_f32 v40, v40, v42
    v_mul_f32 v41, v41, v43
    v_cvt_pk_bf16_f32 v44, v40, v41
    v_lshlrev_b32 v40, 16, v44
    v_and_b32 v41, 0xffff0000, v44
    v_fma_f32 v45, v40, v132, v45
    v_fma_f32 v45, v41, v133, v45
    v_mul_f32 v40, s58, v78
    v_mul_f32 v41, s58, v79
    v_cvt_pk_bf16_f32 v44, v40, v41
    v_lshlrev_b32 v40, 16, v44
    v_and_b32 v41, 0xffff0000, v44
    v_add_f32 v40, v40, v106
    v_add_f32 v41, v41, v107
    v_cvt_pk_bf16_f32 v44, v40, v41
    v_lshlrev_b32 v40, 16, v44
    v_and_b32 v41, 0xffff0000, v44
    v_mul_f32 v42, v40, v40
    v_mul_f32 v43, v41, v41
    v_fma_f32 v42, v42, v58, v57
    v_fma_f32 v43, v43, v58, v57
    v_mul_f32 v42, v42, v40
    v_mul_f32 v43, v43, v41
    v_exp_f32 v42, v42
    v_exp_f32 v43, v43
    v_add_f32 v42, 1.0, v42
    v_add_f32 v43, 1.0, v43
    v_rcp_f32 v42, v42
    v_rcp_f32 v43, v43
    v_mul_f32 v40, v40, v42
    v_mul_f32 v41, v41, v43
    v_cvt_pk_bf16_f32 v44, v40, v41
    v_lshlrev_b32 v40, 16, v44
    v_and_b32 v41, 0xffff0000, v44
    v_fma_f32 v45, v40, v134, v45
    v_fma_f32 v45, v41, v135, v45
    v_mul_f32 v40, s58, v80
    v_mul_f32 v41, s58, v81
    v_cvt_pk_bf16_f32 v44, v40, v41
    v_lshlrev_b32 v40, 16, v44
    v_and_b32 v41, 0xffff0000, v44
    v_add_f32 v40, v40, v108
    v_add_f32 v41, v41, v109
    v_cvt_pk_bf16_f32 v44, v40, v41
    v_lshlrev_b32 v40, 16, v44
    v_and_b32 v41, 0xffff0000, v44
    v_mul_f32 v42, v40, v40
    v_mul_f32 v43, v41, v41
    v_fma_f32 v42, v42, v58, v57
    v_fma_f32 v43, v43, v58, v57
    v_mul_f32 v42, v42, v40
    v_mul_f32 v43, v43, v41
    v_exp_f32 v42, v42
    v_exp_f32 v43, v43
    v_add_f32 v42, 1.0, v42
    v_add_f32 v43, 1.0, v43
    v_rcp_f32 v42, v42
    v_rcp_f32 v43, v43
    v_mul_f32 v40, v40, v42
    v_mul_f32 v41, v41, v43
    v_cvt_pk_bf16_f32 v44, v40, v41
    v_lshlrev_b32 v40, 16, v44
    v_and_b32 v41, 0xffff0000, v44
    v_fma_f32 v45, v40, v136, v45
    v_fma_f32 v45, v41, v137, v45
    v_mul_f32 v40, s58, v82
    v_mul_f32 v41, s58, v83
    v_cvt_pk_bf16_f32 v44, v40, v41
    v_lshlrev_b32 v40, 16, v44
    v_and_b32 v41, 0xffff0000, v44
    v_add_f32 v40, v40, v110
    v_add_f32 v41, v41, v111
    v_cvt_pk_bf16_f32 v44, v40, v41
    v_lshlrev_b32 v40, 16, v44
    v_and_b32 v41, 0xffff0000, v44
    v_mul_f32 v42, v40, v40
    v_mul_f32 v43, v41, v41
    v_fma_f32 v42, v42, v58, v57
    v_fma_f32 v43, v43, v58, v57
    v_mul_f32 v42, v42, v40
    v_mul_f32 v43, v43, v41
    v_exp_f32 v42, v42
    v_exp_f32 v43, v43
    v_add_f32 v42, 1.0, v42
    v_add_f32 v43, 1.0, v43
    v_rcp_f32 v42, v42
    v_rcp_f32 v43, v43
    v_mul_f32 v40, v40, v42
    v_mul_f32 v41, v41, v43
    v_cvt_pk_bf16_f32 v44, v40, v41
    v_lshlrev_b32 v40, 16, v44
    v_and_b32 v41, 0xffff0000, v44
    v_fma_f32 v45, v40, v138, v45
    v_fma_f32 v45, v41, v139, v45
    v_mul_f32 v40, s58, v84
    v_mul_f32 v41, s58, v85
    v_cvt_pk_bf16_f32 v44, v40, v41
    v_lshlrev_b32 v40, 16, v44
    v_and_b32 v41, 0xffff0000, v44
    v_add_f32 v40, v40, v112
    v_add_f32 v41, v41, v113
    v_cvt_pk_bf16_f32 v44, v40, v41
    v_lshlrev_b32 v40, 16, v44
    v_and_b32 v41, 0xffff0000, v44
    v_mul_f32 v42, v40, v40
    v_mul_f32 v43, v41, v41
    v_fma_f32 v42, v42, v58, v57
    v_fma_f32 v43, v43, v58, v57
    v_mul_f32 v42, v42, v40
    v_mul_f32 v43, v43, v41
    v_exp_f32 v42, v42
    v_exp_f32 v43, v43
    v_add_f32 v42, 1.0, v42
    v_add_f32 v43, 1.0, v43
    v_rcp_f32 v42, v42
    v_rcp_f32 v43, v43
    v_mul_f32 v40, v40, v42
    v_mul_f32 v41, v41, v43
    v_cvt_pk_bf16_f32 v44, v40, v41
    v_lshlrev_b32 v40, 16, v44
    v_and_b32 v41, 0xffff0000, v44
    v_fma_f32 v45, v40, v140, v45
    v_fma_f32 v45, v41, v141, v45
    v_mul_f32 v40, s58, v86
    v_mul_f32 v41, s58, v87
    v_cvt_pk_bf16_f32 v44, v40, v41
    v_lshlrev_b32 v40, 16, v44
    v_and_b32 v41, 0xffff0000, v44
    v_add_f32 v40, v40, v114
    v_add_f32 v41, v41, v115
    v_cvt_pk_bf16_f32 v44, v40, v41
    v_lshlrev_b32 v40, 16, v44
    v_and_b32 v41, 0xffff0000, v44
    v_mul_f32 v42, v40, v40
    v_mul_f32 v43, v41, v41
    v_fma_f32 v42, v42, v58, v57
    v_fma_f32 v43, v43, v58, v57
    v_mul_f32 v42, v42, v40
    v_mul_f32 v43, v43, v41
    v_exp_f32 v42, v42
    v_exp_f32 v43, v43
    v_add_f32 v42, 1.0, v42
    v_add_f32 v43, 1.0, v43
    v_rcp_f32 v42, v42
    v_rcp_f32 v43, v43
    v_mul_f32 v40, v40, v42
    v_mul_f32 v41, v41, v43
    v_cvt_pk_bf16_f32 v44, v40, v41
    v_lshlrev_b32 v40, 16, v44
    v_and_b32 v41, 0xffff0000, v44
    v_fma_f32 v45, v40, v142, v45
    v_fma_f32 v45, v41, v143, v45
    v_mul_f32 v40, s58, v88
    v_mul_f32 v41, s58, v89
    v_cvt_pk_bf16_f32 v44, v40, v41
    v_lshlrev_b32 v40, 16, v44
    v_and_b32 v41, 0xffff0000, v44
    v_add_f32 v40, v40, v116
    v_add_f32 v41, v41, v117
    v_cvt_pk_bf16_f32 v44, v40, v41
    v_lshlrev_b32 v40, 16, v44
    v_and_b32 v41, 0xffff0000, v44
    v_mul_f32 v42, v40, v40
    v_mul_f32 v43, v41, v41
    v_fma_f32 v42, v42, v58, v57
    v_fma_f32 v43, v43, v58, v57
    v_mul_f32 v42, v42, v40
    v_mul_f32 v43, v43, v41
    v_exp_f32 v42, v42
    v_exp_f32 v43, v43
    v_add_f32 v42, 1.0, v42
    v_add_f32 v43, 1.0, v43
    v_rcp_f32 v42, v42
    v_rcp_f32 v43, v43
    v_mul_f32 v40, v40, v42
    v_mul_f32 v41, v41, v43
    v_cvt_pk_bf16_f32 v44, v40, v41
    v_lshlrev_b32 v40, 16, v44
    v_and_b32 v41, 0xffff0000, v44
    v_fma_f32 v45, v40, v144, v45
    v_fma_f32 v45, v41, v145, v45
    v_mul_f32 v40, s58, v90
    v_mul_f32 v41, s58, v91
    v_cvt_pk_bf16_f32 v44, v40, v41
    v_lshlrev_b32 v40, 16, v44
    v_and_b32 v41, 0xffff0000, v44
    v_add_f32 v40, v40, v118
    v_add_f32 v41, v41, v119
    v_cvt_pk_bf16_f32 v44, v40, v41
    v_lshlrev_b32 v40, 16, v44
    v_and_b32 v41, 0xffff0000, v44
    v_mul_f32 v42, v40, v40
    v_mul_f32 v43, v41, v41
    v_fma_f32 v42, v42, v58, v57
    v_fma_f32 v43, v43, v58, v57
    v_mul_f32 v42, v42, v40
    v_mul_f32 v43, v43, v41
    v_exp_f32 v42, v42
    v_exp_f32 v43, v43
    v_add_f32 v42, 1.0, v42
    v_add_f32 v43, 1.0, v43
    v_rcp_f32 v42, v42
    v_rcp_f32 v43, v43
    v_mul_f32 v40, v40, v42
    v_mul_f32 v41, v41, v43
    v_cvt_pk_bf16_f32 v44, v40, v41
    v_lshlrev_b32 v40, 16, v44
    v_and_b32 v41, 0xffff0000, v44
    v_fma_f32 v45, v40, v146, v45
    v_fma_f32 v45, v41, v147, v45
    s_nop 1
    v_add_f32_dpp v45, v45, v45 row_ror:8 row_mask:0xf bank_mask:0xf
    s_nop 1
    v_add_f32_dpp v45, v45, v45 row_ror:4 row_mask:0xf bank_mask:0xf
    s_nop 1
    v_add_f32_dpp v45, v45, v45 row_ror:2 row_mask:0xf bank_mask:0xf
    s_nop 1
    v_add_f32_dpp v45, v45, v45 row_ror:1 row_mask:0xf bank_mask:0xf
    s_nop 0
    v_readlane_b32 s60, v45, 0
    v_readlane_b32 s61, v45, 16
    v_readlane_b32 s62, v45, 32
    v_readlane_b32 s63, v45, 48
    s_nop 0
    v_mov_b32 v40, s60
    v_add_f32 v40, s61, v40
    v_add_f32 v40, s62, v40
    v_add_f32 v40, s63, v40
    v_cvt_pk_bf16_f32 v40, v40, v40
    v_and_b32 v40, 0xffff0000, v40
    v_add_f32 v40, s78, v40
    v_cvt_pk_bf16_f32 v40, v40, v40
    v_and_b32 v40, 0xffff0000, v40
    v_mul_f32 v42, 0xbfb8aa3b, v40
    v_exp_f32 v42, v42
    s_nop 0
    v_add_f32 v42, 1.0, v42
    v_rcp_f32 v43, v42
    s_nop 0
    v_mul_f32 v41, v40, v43
    v_cvt_pk_bf16_f32 v41, v41, v41
    v_and_b32 v41, 0xffff0000, v41
    v_cmp_eq_u32 vcc, s57, v1
    s_nop 1
    v_cndmask_b32 v56, v56, v41, vcc
    s_add_u32 s57, s57, 1
    s_and_b32 s56, s57, 8
    s_add_u32 s57, s57, s56
    s_cmp_lt_u32 s57, 64
    s_cbranch_scc1 L_gate
    s_setprio 0
L_nogate:
    s_mov_b32 s52, s24
    s_mov_b32 s53, s25
    s_mov_b32 s54, 0x400000
    s_mov_b32 s55, 0x20000
    v_lshlrev_b32 v48, 4, v3
    v_lshl_add_u32 v48, v2, 10, v48
    s_lshl_b32 s45, s43, 17
    s_lshl_b32 s56, s44, 8
    s_add_u32 s45, s45, s56
    s_lshl_b32 s57, s42, 13
    s_add_u32 s58, s45, s57
    buffer_load_dwordx4 v[64:67], v48, s[52:55], s58 offen
    s_add_u32 s57, s57, 4096
    s_and_b32 s57, s57, 65535
    s_add_u32 s58, s45, s57
    buffer_load_dwordx4 v[68:71], v48, s[52:55], s58 offen
    s_add_u32 s57, s57, 4096
    s_and_b32 s57, s57, 65535
    s_add_u32 s58, s45, s57
    s_waitcnt vmcnt(1)
    buffer_load_dwordx4 v[72:75], v48, s[52:55], s58 offen
    s_add_u32 s57, s57, 4096
    s_and_b32 s57, s57, 65535
    s_add_u32 s58, s45, s57
    s_waitcnt vmcnt(1)
    buffer_load_dwordx4 v[76:79], v48, s[52:55], s58 offen
    s_add_u32 s57, s57, 4096
    s_and_b32 s57, s57, 65535
    s_add_u32 s58, s45, s57
    s_waitcnt vmcnt(1)
    buffer_load_dwordx4 v[80:83], v48, s[52:55], s58 offen
    s_add_u32 s57, s57, 4096
    s_and_b32 s57, s57, 65535
    s_add_u32 s58, s45, s57
    s_waitcnt vmcnt(1)
    buffer_load_dwordx4 v[84:87], v48, s[52:55], s58 offen
    s_add_u32 s57, s57, 4096
    s_and_b32 s57, s57, 65535
    s_add_u32 s58, s45, s57
    s_waitcnt vmcnt(1)
    buffer_load_dwordx4 v[88:91], v48, s[52:55], s58 offen
    s_add_u32 s57, s57, 4096
    s_and_b32 s57, s57, 65535
    s_add_u32 s58, s45, s57
    s_waitcnt vmcnt(1)
    buffer_load_dwordx4 v[92:95], v48, s[52:55], s58 offen
    s_add_u32 s57, s57, 4096
    s_and_b32 s57, s57, 65535
    s_add_u32 s58, s45, s57
    s_waitcnt vmcnt(1)
    buffer_load_dwordx4 v[96:99], v48, s[52:55], s58 offen
    s_add_u32 s57, s57, 4096
    s_and_b32 s57, s57, 65535
    s_add_u32 s58, s45, s57
    s_waitcnt vmcnt(1)
    buffer_load_dwordx4 v[100:103], v48, s[52:55], s58 offen
    s_add_u32 s57, s57, 4096
    s_and_b32 s57, s57, 65535
    s_add_u32 s58, s45, s57
    s_waitcnt vmcnt(1)
    buffer_load_dwordx4 v[104:107], v48, s[52:55], s58 offen
    s_add_u32 s57, s57, 4096
    s_and_b32 s57, s57, 65535
    s_add_u32 s58, s45, s57
    s_waitcnt vmcnt(1)
    buffer_load_dwordx4 v[108:111], v48, s[52:55], s58 offen
    s_add_u32 s57, s57, 4096
    s_and_b32 s57, s57, 65535
    s_add_u32 s58, s45, s57
    s_waitcnt vmcnt(1)
    buffer_load_dwordx4 v[112:115], v48, s[52:55], s58 offen
    s_add_u32 s57, s57, 4096
    s_and_b32 s57, s57, 65535
    s_add_u32 s58, s45, s57
    s_waitcnt vmcnt(1)
    buffer_load_dwordx4 v[116:119], v48, s[52:55], s58 offen
    s_add_u32 s57, s57, 4096
    s_and_b32 s57, s57, 65535
    s_add_u32 s58, s45, s57
    s_waitcnt vmcnt(1)
    buffer_load_dwordx4 v[120:123], v48, s[52:55], s58 offen
    s_add_u32 s57, s57, 4096
    s_and_b32 s57, s57, 65535
    s_add_u32 s58, s45, s57
    s_waitcnt vmcnt(1)
    buffer_load_dwordx4 v[124:127], v48, s[52:55], s58 offen
    s_add_u32 s57, s57, 4096
    s_and_b32 s57, s57, 65535
    s_add_u32 s45, s45, 65536
    s_add_u32 s58, s45, s57
    s_waitcnt vmcnt(1)
    buffer_load_dwordx4 v[128:131], v48, s[52:55], s58 offen
    s_add_u32 s57, s57, 4096
    s_and_b32 s57, s57, 65535
    s_add_u32 s58, s45, s57
    s_waitcnt vmcnt(1)
    buffer_load_dwordx4 v[132:135], v48, s[52:55], s58 offen
    s_add_u32 s57, s57, 4096
    s_and_b32 s57, s57, 65535
    s_add_u32 s58, s45, s57
    s_waitcnt vmcnt(1)
    buffer_load_dwordx4 v[136:139], v48, s[52:55], s58 offen
    s_add_u32 s57, s57, 4096
    s_and_b32 s57, s57, 65535
    s_add_u32 s58, s45, s57
    s_waitcnt vmcnt(1)
    buffer_load_dwordx4 v[140:143], v48, s[52:55], s58 offen
    s_add_u32 s57, s57, 4096
    s_and_b32 s57, s57, 65535
    s_add_u32 s58, s45, s57
    s_waitcnt vmcnt(1)
    buffer_load_dwordx4 v[144:147], v48, s[52:55], s58 offen
    s_add_u32 s57, s57, 4096
    s_and_b32 s57, s57, 65535
    s_add_u32 s58, s45, s57
    s_waitcnt vmcnt(1)
    buffer_load_dwordx4 v[148:151], v48, s[52:55], s58 offen
    s_add_u32 s57, s57, 4096
    s_and_b32 s57, s57, 65535
    s_add_u32 s58, s45, s57
    s_waitcnt vmcnt(1)
    buffer_load_dwordx4 v[152:155], v48, s[52:55], s58 offen
    s_add_u32 s57, s57, 4096
    s_and_b32 s57, s57, 65535
    s_add_u32 s58, s45, s57
    s_waitcnt vmcnt(1)
    buffer_load_dwordx4 v[156:159], v48, s[52:55], s58 offen
    s_add_u32 s57, s57, 4096
    s_and_b32 s57, s57, 65535
    s_add_u32 s58, s45, s57
    s_waitcnt vmcnt(1)
    buffer_load_dwordx4 v[160:163], v48, s[52:55], s58 offen
    s_add_u32 s57, s57, 4096
    s_and_b32 s57, s57, 65535
    s_add_u32 s58, s45, s57
    s_waitcnt vmcnt(1)
    buffer_load_dwordx4 v[164:167], v48, s[52:55], s58 offen
    s_add_u32 s57, s57, 4096
    s_and_b32 s57, s57, 65535
    s_add_u32 s58, s45, s57
    s_waitcnt vmcnt(1)
    buffer_load_dwordx4 v[168:171], v48, s[52:55], s58 offen
    s_add_u32 s57, s57, 4096
    s_and_b32 s57, s57, 65535
    s_add_u32 s58, s45, s57
    s_waitcnt vmcnt(1)
    buffer_load_dwordx4 v[172:175], v48, s[52:55], s58 offen
    s_add_u32 s57, s57, 4096
    s_and_b32 s57, s57, 65535
    s_add_u32 s58, s45, s57
    s_waitcnt vmcnt(1)
    buffer_load_dwordx4 v[176:179], v48, s[52:55], s58 offen
    s_add_u32 s57, s57, 4096
    s_and_b32 s57, s57, 65535
    s_add_u32 s58, s45, s57
    s_waitcnt vmcnt(1)
    buffer_load_dwordx4 v[180:183], v48, s[52:55], s58 offen
    s_add_u32 s57, s57, 4096
    s_and_b32 s57, s57, 65535
    s_add_u32 s58, s45, s57
    s_waitcnt vmcnt(1)
    buffer_load_dwordx4 v[184:187], v48, s[52:55], s58 offen
    s_add_u32 s57, s57, 4096
    s_and_b32 s57, s57, 65535
    s_add_u32 s58, s45, s57
    s_waitcnt vmcnt(1)
    buffer_load_dwordx4 v[188:191], v48, s[52:55], s58 offen
    s_add_u32 s57, s57, 4096
    s_and_b32 s57, s57, 65535
    s_waitcnt vmcnt(0)
    s_waitcnt vmcnt(0) lgkmcnt(0)
    v_and_b32 v8, 1, v8
    v_xor_b32 v8, 1, v8
    v_and_b32 v9, 1, v9
    v_xor_b32 v9, 1, v9
    v_and_b32 v10, 1, v10
    v_xor_b32 v10, 1, v10
    v_and_b32 v11, 1, v11
    v_xor_b32 v11, 1, v11
    s_cmp_eq_u32 s44, 3
    s_cbranch_scc1 L_nobar2
    s_barrier
L_nobar2:
    s_cmp_lg_u32 s44, 0
    s_cbranch_scc1 L_cpoll_done
    s_lshl_b32 s82, s42, 4
    v_mov_b32 v40, 0
    s_mov_b32 s57, 0
L_cpoll:
    buffer_load_dwordx4 v[44:47], v40, s[68:71], s82 offen sc1
    s_waitcnt vmcnt(0)
    v_and_b32 v44, v44, v45
    v_and_b32 v46, v46, v47
    v_and_b32 v44, v44, v46
    s_add_u32 s57, s57, 1
    v_readfirstlane_b32 s56, v44
    s_cmp_ge_u32 s57, 0x400000
    s_cbranch_scc1 L_cpoll_done
    s_cmp_lg_u32 s56, 0
    s_cbranch_scc1 L_cpoll_done
    s_sleep 32
    s_branch L_cpoll
L_cpoll_done:
    v_and_b32 v42, 3, v1
    v_lshlrev_b32 v42, 4, v42
    s_lshl_b32 s56, s42, 1
    v_add_u32 v40, s56, v3
    v_and_b32 v40, 15, v40
    v_lshlrev_b32 v40, 4, v40
    v_lshl_add_u32 v40, v2, 2, v40
    s_cmp_lg_u32 s44, 2
    s_cbranch_scc1 L_cskipv
    v_lshlrev_b32 v246, 3, v1
    s_mov_b64 exec, 0xff
    ds_read_b64 v[236:237], v246 offset:2560
    s_mov_b64 exec, 1
    ds_read_b128 v[232:235], v248 offset:2304
    s_waitcnt lgkmcnt(0)
    v_add_u32 v232, v232, v233
    v_add3_u32 v243, v232, v234, v235
    s_nop 1
    v_readfirstlane_b32 s6, v243
L_cloopv:
    s_sleep 16
    s_mov_b64 exec, 15
    ds_read_b32 v250, v239 offset:2304
    s_mov_b64 exec, 1
    ds_read_b128 v[232:235], v248 offset:2304
    s_waitcnt lgkmcnt(0)
    v_add_u32 v232, v232, v233
    v_add3_u32 v243, v232, v234, v235
    s_nop 1
    v_readfirstlane_b32 s8, v243
    s_nop 0
    s_cmp_ge_u32 s8, 1000
    s_cbranch_scc1 L_cexitv
    buffer_store_dword v243, v238, s[64:67], s4 offen
    s_mov_b32 exec_lo, -1
    s_mov_b32 exec_hi, 1
    buffer_load_dword v244, v239, s[64:67], s4 offen sc1
    s_add_u32 s7, s7, 1
    s_cmp_ge_u32 s7, 6
    s_cselect_b32 s7, 0, s7
    s_cmp_ge_u32 s2, 8
    s_cbranch_scc1 L_cn1v
    s_mov_b64 exec, 0xff
    buffer_load_dword v245, v240, s[64:67], s5 offen sc1
L_cn1v:
    s_mov_b64 exec, -1
    s_sub_i32 s56, s8, 64
    s_add_i32 s57, s8, 64
    v_mov_b32 v246, s57
    v_lshlrev_b32 v250, 2, v250
    v_subrev_u32 v250, s8, v250
    v_ashrrev_i32 v251, 1, v251
    v_add_u32 v251, v251, v250
    v_mul_i32_i24 v250, 12, v251
    s_waitcnt vmcnt(0)
    v_readlane_b32 s9, v244, 32
    v_med3_i32 v244, v244, s56, v246
    s_nop 1
    v_add_u32_dpp v244, v244, v244 row_ror:8 row_mask:0xf bank_mask:0xf
    s_nop 1
    v_add_u32_dpp v244, v244, v244 row_ror:4 row_mask:0xf bank_mask:0xf
    s_nop 1
    v_add_u32_dpp v244, v244, v244 row_ror:2 row_mask:0xf bank_mask:0xf
    s_nop 1
    v_add_u32_dpp v244, v244, v244 row_ror:1 row_mask:0xf bank_mask:0xf
    s_nop 0
    v_readlane_b32 s10, v244, 0
    v_readlane_b32 s56, v244, 16
    s_nop 3
    s_add_u32 s10, s10, s56
    s_cmp_ge_u32 s2, 8
    s_cbranch_scc1 L_cn2v
    v_cmp_ne_u32 vcc, v245, v236
    v_sub_u32 v246, s10, v245
    v_subrev_u32 v246, 220, v246
    v_add_u32 v247, 768, v246
    v_cmp_gt_u32 s[56:57], s94, v247
    s_and_b64 vcc, vcc, s[56:57]
    v_cndmask_b32 v237, v237, v246, vcc
    v_mov_b32 v236, v245
    v_writelane_b32 v237, 0, s2
    s_nop 0
    v_readlane_b32 s18, v237, 0
    v_readlane_b32 s19, v237, 1
    v_readlane_b32 s20, v237, 2
    v_readlane_b32 s21, v237, 3
    v_readlane_b32 s22, v237, 4
    v_readlane_b32 s23, v237, 5
    v_readlane_b32 s26, v237, 6
    v_readlane_b32 s27, v237, 7
    s_nop 3
    s_add_u32 s18, s18, s19
    s_add_u32 s18, s18, s20
    s_add_u32 s18, s18, s21
    s_add_u32 s18, s18, s22
    s_add_u32 s18, s18, s23
    s_add_u32 s18, s18, s26
    s_add_u32 s18, s18, s27
    s_ashr_i32 s9, s18, 3
    s_mov_b64 exec, 1
    v_mov_b32 v246, s10
    v_mov_b32 v247, s9
    buffer_store_dword v247, v242, s[64:67], s4 offen
    s_cmp_lg_u32 s7, 0
    s_cbranch_scc1 L_cn2v
    buffer_store_dword v246, v241, s[64:67], s5 offen sc1
L_cn2v:
    s_add_u32 s11, s8, s6
    s_lshl_b32 s11, s11, 4
    s_sub_i32 s11, s11, s10
    s_add_i32 s11, s11, s9
    s_mov_b32 s6, s8
    s_mov_b32 s12, 1
    s_cmp_gt_i32 s11, 24
    s_cselect_b32 s12, 2, s12
    s_cmp_lt_i32 s11, -72
    s_cselect_b32 s12, 0, s12
    s_mov_b64 exec, 15
    v_add_u32 v250, s11, v250
    v_cmp_lt_i32 vcc, 24, v250
    v_mov_b32 v246, 1
    s_nop 0
    v_cndmask_b32 v246, v246, 2, vcc
    v_cmp_gt_i32 vcc, -72, v250
    s_nop 1
    v_cndmask_b32 v246, v246, 0, vcc
    ds_write_b32 v239, v246 offset:2320
    s_branch L_cloopv
L_cexitv:
    v_add_u32 v243, 32, v243
    buffer_store_dword v243, v238, s[64:67], s4 offen
    s_mov_b64 exec, -1
L_cskipv:
    s_setprio 3
    s_barrier
    ds_read2st64_b32 v[16:17], v40 offset0:16 offset1:17
    ds_read2st64_b32 v[18:19], v40 offset0:18 offset1:19
    ds_read2st64_b32 v[20:21], v40 offset0:20 offset1:21
    ds_read2st64_b32 v[22:23], v40 offset0:22 offset1:23
    s_waitcnt lgkmcnt(0)
    v_add_f32 v16, v16, v18
    v_add_f32 v20, v20, v22
    v_add_f32 v17, v17, v19
    v_add_f32 v21, v21, v23
    v_add_f32 v16, v16, v20
    v_add_f32 v17, v17, v21
    v_cvt_pk_bf16_f32 v12, v16, v16
    v_cvt_pk_bf16_f32 v13, v17, v17
    s_nop 1
    v_and_b32_dpp v28, v12, v4 row_newbcast:0 row_mask:0xf bank_mask:0xf
    v_and_b32_dpp v29, v12, v5 row_newbcast:0 row_mask:0xf bank_mask:0xf
    v_and_b32_dpp v30, v12, v6 row_newbcast:0 row_mask:0xf bank_mask:0xf
    v_and_b32_dpp v31, v12, v7 row_newbcast:0 row_mask:0xf bank_mask:0xf
    v_and_b32_dpp v32, v12, v4 row_newbcast:1 row_mask:0xf bank_mask:0xf
    v_and_b32_dpp v33, v12, v5 row_newbcast:1 row_mask:0xf bank_mask:0xf
    v_and_b32_dpp v34, v12, v6 row_newbcast:1 row_mask:0xf bank_mask:0xf
    v_and_b32_dpp v35, v12, v7 row_newbcast:1 row_mask:0xf bank_mask:0xf
    v_mfma_f32_16x16x32_bf16 v[36:39], v[28:31], v[64:67], 0
    v_and_b32_dpp v28, v12, v4 row_newbcast:2 row_mask:0xf bank_mask:0xf
    v_and_b32_dpp v29, v12, v5 row_newbcast:2 row_mask:0xf bank_mask:0xf
    v_and_b32_dpp v30, v12, v6 row_newbcast:2 row_mask:0xf bank_mask:0xf
    v_and_b32_dpp v31, v12, v7 row_newbcast:2 row_mask:0xf bank_mask:0xf
    v_mfma_f32_16x16x32_bf16 v[36:39], v[32:35], v[68:71], v[36:39]
    v_and_b32_dpp v32, v12, v4 row_newbcast:3 row_mask:0xf bank_mask:0xf
    v_and_b32_dpp v33, v12, v5 row_newbcast:3 row_mask:0xf bank_mask:0xf
    v_and_b32_dpp v34, v12, v6 row_newbcast:3 row_mask:0xf bank_mask:0xf
    v_and_b32_dpp v35, v12, v7 row_newbcast:3 row_mask:0xf bank_mask:0xf
    v_mfma_f32_16x16x32_bf16 v[36:39], v[28:31], v[72:75], v[36:39]
    v_and_b32_dpp v28, v12, v4 row_newbcast:4 row_mask:0xf bank_mask:0xf
    v_and_b32_dpp v29, v12, v5 row_newbcast:4 row_mask:0xf bank_mask:0xf
    v_and_b32_dpp v30, v12, v6 row_newbcast:4 row_mask:0xf bank_mask:0xf
    v_and_b32_dpp v31, v12, v7 row_newbcast:4 row_mask:0xf bank_mask:0xf
    v_mfma_f32_16x16x32_bf16 v[36:39], v[32:35], v[76:79], v[36:39]
    v_and_b32_dpp v32, v12, v4 row_newbcast:5 row_mask:0xf bank_mask:0xf
    v_and_b32_dpp v33, v12, v5 row_newbcast:5 row_mask:0xf bank_mask:0xf
    v_and_b32_dpp v34, v12, v6 row_newbcast:5 row_mask:0xf bank_mask:0xf
    v_and_b32_dpp v35, v12, v7 row_newbcast:5 row_mask:0xf bank_mask:0xf
    v_mfma_f32_16x16x32_bf16 v[36:39], v[28:31], v[80:83], v[36:39]
    v_and_b32_dpp v28, v12, v4 row_newbcast:6 row_mask:0xf bank_mask:0xf
    v_and_b32_dpp v29, v12, v5 row_newbcast:6 row_mask:0xf bank_mask:0xf
    v_and_b32_dpp v30, v12, v6 row_newbcast:6 row_mask:0xf bank_mask:0xf
    v_and_b32_dpp v31, v12, v7 row_newbcast:6 row_mask:0xf bank_mask:0xf
    v_mfma_f32_16x16x32_bf16 v[36:39], v[32:35], v[84:87], v[36:39]
    v_and_b32_dpp v32, v12, v4 row_newbcast:7 row_mask:0xf bank_mask:0xf
    v_and_b32_dpp v33, v12, v5 row_newbcast:7 row_mask:0xf bank_mask:0xf
    v_and_b32_dpp v34, v12, v6 row_newbcast:7 row_mask:0xf bank_mask:0xf
    v_and_b32_dpp v35, v12, v7 row_newbcast:7 row_mask:0xf bank_mask:0xf
    v_mfma_f32_16x16x32_bf16 v[36:39], v[28:31], v[88:91], v[36:39]
    v_and_b32_dpp v28, v12, v4 row_newbcast:8 row_mask:0xf bank_mask:0xf
    v_and_b32_dpp v29, v12, v5 row_newbcast:8 row_mask:0xf bank_mask:0xf
    v_and_b32_dpp v30, v12, v6 row_newbcast:8 row_mask:0xf bank_mask:0xf
    v_and_b32_dpp v31, v12, v7 row_newbcast:8 row_mask:0xf bank_mask:0xf
    v_mfma_f32_16x16x32_bf16 v[36:39], v[32:35], v[92:95], v[36:39]
    v_and_b32_dpp v32, v12, v4 row_newbcast:9 row_mask:0xf bank_mask:0xf
    v_and_b32_dpp v33, v12, v5 row_newbcast:9 row_mask:0xf bank_mask:0xf
    v_and_b32_dpp v34, v12, v6 row_newbcast:9 row_mask:0xf bank_mask:0xf
    v_and_b32_dpp v35, v12, v7 row_newbcast:9 row_mask:0xf bank_mask:0xf
    v_mfma_f32_16x16x32_bf16 v[36:39], v[28:31], v[96:99], v[36:39]
    v_and_b32_dpp v28, v12, v4 row_newbcast:10 row_mask:0xf bank_mask:0xf
    v_and_b32_dpp v29, v12, v5 row_newbcast:10 row_mask:0xf bank_mask:0xf
    v_and_b32_dpp v30, v12, v6 row_newbcast:10 row_mask:0xf bank_mask:0xf
    v_and_b32_dpp v31, v12, v7 row_newbcast:10 row_mask:0xf bank_mask:0xf
    v_mfma_f32_16x16x32_bf16 v[36:39], v[32:35], v[100:103], v[36:39]
    v_and_b32_dpp v32, v12, v4 row_newbcast:11 row_mask:0xf bank_mask:0xf
    v_and_b32_dpp v33, v12, v5 row_newbcast:11 row_mask:0xf bank_mask:0xf
    v_and_b32_dpp v34, v12, v6 row_newbcast:11 row_mask:0xf bank_mask:0xf
    v_and_b32_dpp v35, v12, v7 row_newbcast:11 row_mask:0xf bank_mask:0xf
    v_mfma_f32_16x16x32_bf16 v[36:39], v[28:31], v[104:107], v[36:39]
    v_and_b32_dpp v28, v12, v4 row_newbcast:12 row_mask:0xf bank_mask:0xf
    v_and_b32_dpp v29, v12, v5 row_newbcast:12 row_mask:0xf bank_mask:0xf
    v_and_b32_dpp v30, v12, v6 row_newbcast:12 row_mask:0xf bank_mask:0xf
    v_and_b32_dpp v31, v12, v7 row_newbcast:12 row_mask:0xf bank_mask:0xf
    v_mfma_f32_16x16x32_bf16 v[36:39], v[32:35], v[108:111], v[36:39]
    v_and_b32_dpp v32, v12, v4 row_newbcast:13 row_mask:0xf bank_mask:0xf
    v_and_b32_dpp v33, v12, v5 row_newbcast:13 row_mask:0xf bank_mask:0xf
    v_and_b32_dpp v34, v12, v6 row_newbcast:13 row_mask:0xf bank_mask:0xf
    v_and_b32_dpp v35, v12, v7 row_newbcast:13 row_mask:0xf bank_mask:0xf
    v_mfma_f32_16x16x32_bf16 v[36:39], v[28:31], v[112:115], v[36:39]
    v_and_b32_dpp v28, v12, v4 row_newbcast:14 row_mask:0xf bank_mask:0xf
    v_and_b32_dpp v29, v12, v5 row_newbcast:14 row_mask:0xf bank_mask:0xf
    v_and_b32_dpp v30, v12, v6 row_newbcast:14 row_mask:0xf bank_mask:0xf
    v_and_b32_dpp v31, v12, v7 row_newbcast:14 row_mask:0xf bank_mask:0xf
    v_mfma_f32_16x16x32_bf16 v[36:39], v[32:35], v[116:119], v[36:39]
    v_and_b32_dpp v32, v12, v4 row_newbcast:15 row_mask:0xf bank_mask:0xf
    v_and_b32_dpp v33, v12, v5 row_newbcast:15 row_mask:0xf bank_mask:0xf
    v_and_b32_dpp v34, v12, v6 row_newbcast:15 row_mask:0xf bank_mask:0xf
    v_and_b32_dpp v35, v12, v7 row_newbcast:15 row_mask:0xf bank_mask:0xf
    v_mfma_f32_16x16x32_bf16 v[36:39], v[28:31], v[120:123], v[36:39]
    v_and_b32_dpp v28, v13, v4 row_newbcast:0 row_mask:0xf bank_mask:0xf
    v_and_b32_dpp v29, v13, v5 row_newbcast:0 row_mask:0xf bank_mask:0xf
    v_and_b32_dpp v30, v13, v6 row_newbcast:0 row_mask:0xf bank_mask:0xf
    v_and_b32_dpp v31, v13, v7 row_newbcast:0 row_mask:0xf bank_mask:0xf
    v_mfma_f32_16x16x32_bf16 v[36:39], v[32:35], v[124:127], v[36:39]
    v_and_b32_dpp v32, v13, v4 row_newbcast:1 row_mask:0xf bank_mask:0xf
    v_and_b32_dpp v33, v13, v5 row_newbcast:1 row_mask:0xf bank_mask:0xf
    v_and_b32_dpp v34, v13, v6 row_newbcast:1 row_mask:0xf bank_mask:0xf
    v_and_b32_dpp v35, v13, v7 row_newbcast:1 row_mask:0xf bank_mask:0xf
    v_mfma_f32_16x16x32_bf16 v[36:39], v[28:31], v[128:131], v[36:39]
    v_and_b32_dpp v28, v13, v4 row_newbcast:2 row_mask:0xf bank_mask:0xf
    v_and_b32_dpp v29, v13, v5 row_newbcast:2 row_mask:0xf bank_mask:0xf
    v_and_b32_dpp v30, v13, v6 row_newbcast:2 row_mask:0xf bank_mask:0xf
    v_and_b32_dpp v31, v13, v7 row_newbcast:2 row_mask:0xf bank_mask:0xf
    v_mfma_f32_16x16x32_bf16 v[36:39], v[32:35], v[132:135], v[36:39]
    v_and_b32_dpp v32, v13, v4 row_newbcast:3 row_mask:0xf bank_mask:0xf
    v_and_b32_dpp v33, v13, v5 row_newbcast:3 row_mask:0xf bank_mask:0xf
    v_and_b32_dpp v34, v13, v6 row_newbcast:3 row_mask:0xf bank_mask:0xf
    v_and_b32_dpp v35, v13, v7 row_newbcast:3 row_mask:0xf bank_mask:0xf
    v_mfma_f32_16x16x32_bf16 v[36:39], v[28:31], v[136:139], v[36:39]
    v_and_b32_dpp v28, v13, v4 row_newbcast:4 row_mask:0xf bank_mask:0xf
    v_and_b32_dpp v29, v13, v5 row_newbcast:4 row_mask:0xf bank_mask:0xf
    v_and_b32_dpp v30, v13, v6 row_newbcast:4 row_mask:0xf bank_mask:0xf
    v_and_b32_dpp v31, v13, v7 row_newbcast:4 row_mask:0xf bank_mask:0xf
    v_mfma_f32_16x16x32_bf16 v[36:39], v[32:35], v[140:143], v[36:39]
    v_and_b32_dpp v32, v13, v4 row_newbcast:5 row_mask:0xf bank_mask:0xf
    v_and_b32_dpp v33, v13, v5 row_newbcast:5 row_mask:0xf bank_mask:0xf
    v_and_b32_dpp v34, v13, v6 row_newbcast:5 row_mask:0xf bank_mask:0xf
    v_and_b32_dpp v35, v13, v7 row_newbcast:5 row_mask:0xf bank_mask:0xf
    v_mfma_f32_16x16x32_bf16 v[36:39], v[28:31], v[144:147], v[36:39]
    v_and_b32_dpp v28, v13, v4 row_newbcast:6 row_mask:0xf bank_mask:0xf
    v_and_b32_dpp v29, v13, v5 row_newbcast:6 row_mask:0xf bank_mask:0xf
    v_and_b32_dpp v30, v13, v6 row_newbcast:6 row_mask:0xf bank_mask:0xf
    v_and_b32_dpp v31, v13, v7 row_newbcast:6 row_mask:0xf bank_mask:0xf
    v_mfma_f32_16x16x32_bf16 v[36:39], v[32:35], v[148:151], v[36:39]
    v_and_b32_dpp v32, v13, v4 row_newbcast:7 row_mask:0xf bank_mask:0xf
    v_and_b32_dpp v33, v13, v5 row_newbcast:7 row_mask:0xf bank_mask:0xf
    v_and_b32_dpp v34, v13, v6 row_newbcast:7 row_mask:0xf bank_mask:0xf
    v_and_b32_dpp v35, v13, v7 row_newbcast:7 row_mask:0xf bank_mask:0xf
    v_mfma_f32_16x16x32_bf16 v[36:39], v[28:31], v[152:155], v[36:39]
    v_and_b32_dpp v28, v13, v4 row_newbcast:8 row_mask:0xf bank_mask:0xf
    v_and_b32_dpp v29, v13, v5 row_newbcast:8 row_mask:0xf bank_mask:0xf
    v_and_b32_dpp v30, v13, v6 row_newbcast:8 row_mask:0xf bank_mask:0xf
    v_and_b32_dpp v31, v13, v7 row_newbcast:8 row_mask:0xf bank_mask:0xf
    v_mfma_f32_16x16x32_bf16 v[36:39], v[32:35], v[156:159], v[36:39]
    v_and_b32_dpp v32, v13, v4 row_newbcast:9 row_mask:0xf bank_mask:0xf
    v_and_b32_dpp v33, v13, v5 row_newbcast:9 row_mask:0xf bank_mask:0xf
    v_and_b32_dpp v34, v13, v6 row_newbcast:9 row_mask:0xf bank_mask:0xf
    v_and_b32_dpp v35, v13, v7 row_newbcast:9 row_mask:0xf bank_mask:0xf
    v_mfma_f32_16x16x32_bf16 v[36:39], v[28:31], v[160:163], v[36:39]
    v_and_b32_dpp v28, v13, v4 row_newbcast:10 row_mask:0xf bank_mask:0xf
    v_and_b32_dpp v29, v13, v5 row_newbcast:10 row_mask:0xf bank_mask:0xf
    v_and_b32_dpp v30, v13, v6 row_newbcast:10 row_mask:0xf bank_mask:0xf
    v_and_b32_dpp v31, v13, v7 row_newbcast:10 row_mask:0xf bank_mask:0xf
    v_mfma_f32_16x16x32_bf16 v[36:39], v[32:35], v[164:167], v[36:39]
    v_and_b32_dpp v32, v13, v4 row_newbcast:11 row_mask:0xf bank_mask:0xf
    v_and_b32_dpp v33, v13, v5 row_newbcast:11 row_mask:0xf bank_mask:0xf
    v_and_b32_dpp v34, v13, v6 row_newbcast:11 row_mask:0xf bank_mask:0xf
    v_and_b32_dpp v35, v13, v7 row_newbcast:11 row_mask:0xf bank_mask:0xf
    v_mfma_f32_16x16x32_bf16 v[36:39], v[28:31], v[168:171], v[36:39]
    v_and_b32_dpp v28, v13, v4 row_newbcast:12 row_mask:0xf bank_mask:0xf
    v_and_b32_dpp v29, v13, v5 row_newbcast:12 row_mask:0xf bank_mask:0xf
    v_and_b32_dpp v30, v13, v6 row_newbcast:12 row_mask:0xf bank_mask:0xf
    v_and_b32_dpp v31, v13, v7 row_newbcast:12 row_mask:0xf bank_mask:0xf
    v_mfma_f32_16x16x32_bf16 v[36:39], v[32:35], v[172:175], v[36:39]
    v_and_b32_dpp v32, v13, v4 row_newbcast:13 row_mask:0xf bank_mask:0xf
    v_and_b32_dpp v33, v13, v5 row_newbcast:13 row_mask:0xf bank_mask:0xf
    v_and_b32_dpp v34, v13, v6 row_newbcast:13 row_mask:0xf bank_mask:0xf
    v_and_b32_dpp v35, v13, v7 row_newbcast:13 row_mask:0xf bank_mask:0xf
    v_mfma_f32_16x16x32_bf16 v[36:39], v[28:31], v[176:179], v[36:39]
    v_and_b32_dpp v28, v13, v4 row_newbcast:14 row_mask:0xf bank_mask:0xf
    v_and_b32_dpp v29, v13, v5 row_newbcast:14 row_mask:0xf bank_mask:0xf
    v_and_b32_dpp v30, v13, v6 row_newbcast:14 row_mask:0xf bank_mask:0xf
    v_and_b32_dpp v31, v13, v7 row_newbcast:14 row_mask:0xf bank_mask:0xf
    v_mfma_f32_16x16x32_bf16 v[36:39], v[32:35], v[180:183], v[36:39]
    v_and_b32_dpp v32, v13, v4 row_newbcast:15 row_mask:0xf bank_mask:0xf
    v_and_b32_dpp v33, v13, v5 row_newbcast:15 row_mask:0xf bank_mask:0xf
    v_and_b32_dpp v34, v13, v6 row_newbcast:15 row_mask:0xf bank_mask:0xf
    v_and_b32_dpp v35, v13, v7 row_newbcast:15 row_mask:0xf bank_mask:0xf
    v_mfma_f32_16x16x32_bf16 v[36:39], v[28:31], v[184:187], v[36:39]
    s_nop 1
    v_mfma_f32_16x16x32_bf16 v[36:39], v[32:35], v[188:191], v[36:39]
    s_mov_b32 exec_hi, 0
    s_nop 6
    v_and_or_b32 v36, v36, -2, v8
    v_and_or_b32 v37, v37, -2, v9
    v_and_or_b32 v38, v38, -2, v10
    v_and_or_b32 v39, v39, -2, v11
    buffer_store_dwordx4 v[36:39], v49, s[64:67], 0 offen sc1
    s_mov_b32 exec_hi, -1
    s_cmp_lg_u32 s83, s42
    s_cbranch_scc1 L_hend
    s_mov_b32 s56, s79
    buffer_load_dwordx4 v[64:67], v15, s[64:67], s56 offen sc1
    s_add_u32 s56, s56, 4096
    buffer_load_dwordx4 v[68:71], v15, s[64:67], s56 offen sc1
    s_add_u32 s56, s56, 4096
    buffer_load_dwordx4 v[72:75], v15, s[64:67], s56 offen sc1
    s_add_u32 s56, s56, 4096
    buffer_load_dwordx4 v[76:79], v15, s[64:67], s56 offen sc1
    s_mov_b32 s56, s79
    buffer_load_dwordx4 v[80:83], v15, s[64:67], s56 offen sc1
    s_add_u32 s56, s56, 4096
    buffer_load_dwordx4 v[84:87], v15, s[64:67], s56 offen sc1
    s_add_u32 s56, s56, 4096
    buffer_load_dwordx4 v[88:91], v15, s[64:67], s56 offen sc1
    s_add_u32 s56, s56, 4096
    buffer_load_dwordx4 v[92:95], v15, s[64:67], s56 offen sc1
    s_mov_b32 s56, s79
    buffer_load_dwordx4 v[96:99], v15, s[64:67], s56 offen sc1
    s_add_u32 s56, s56, 4096
    buffer_load_dwordx4 v[100:103], v15, s[64:67], s56 offen sc1
    s_add_u32 s56, s56, 4096
    buffer_load_dwordx4 v[104:107], v15, s[64:67], s56 offen sc1
    s_add_u32 s56, s56, 4096
    buffer_load_dwordx4 v[108:111], v15, s[64:67], s56 offen sc1
    s_mov_b32 s57, 0
    s_add_u32 s82, s46, s81
L_gpoll:
    s_waitcnt vmcnt(11)
    v_alignbit_b32 v41, v64, v41, 1
    v_alignbit_b32 v41, v65, v41, 1
    v_alignbit_b32 v41, v66, v41, 1
    v_alignbit_b32 v41, v67, v41, 1
    s_waitcnt vmcnt(10)
    v_alignbit_b32 v41, v68, v41, 1
    v_alignbit_b32 v41, v69, v41, 1
    v_alignbit_b32 v41, v70, v41, 1
    v_alignbit_b32 v41, v71, v41, 1
    v_add_f32 v36, v64, v68
    v_add_f32 v37, v65, v69
    v_add_f32 v38, v66, v70
    v_add_f32 v39, v67, v71
    s_waitcnt vmcnt(9)
    v_alignbit_b32 v41, v72, v41, 1
    v_alignbit_b32 v41, v73, v41, 1
    v_alignbit_b32 v41, v74, v41, 1
    v_alignbit_b32 v41, v75, v41, 1
    v_add_f32 v36, v36, v72
    v_add_f32 v37, v37, v73
    v_add_f32 v38, v38, v74
    v_add_f32 v39, v39, v75
    s_waitcnt vmcnt(8)
    v_alignbit_b32 v41, v76, v41, 1
    v_alignbit_b32 v41, v77, v41, 1
    v_alignbit_b32 v41, v78, v41, 1
    v_alignbit_b32 v41, v79, v41, 1
    v_add_f32 v36, v36, v76
    v_add_f32 v37, v37, v77
    v_add_f32 v38, v38, v78
    v_add_f32 v39, v39, v79
    v_xor_b32 v41, v41, v53
    v_cmp_gt_u32 vcc, 0xffff0000, v41
    v_permlane32_swap_b32 v36, v37
    v_permlane32_swap_b32 v38, v39
    v_add_f32 v36, v36, v37
    v_add_f32 v38, v38, v39
    s_cbranch_vccz L_gdone
    s_mov_b32 s56, s79
    buffer_load_dwordx4 v[64:67], v15, s[64:67], s56 offen sc1
    s_add_u32 s56, s56, 4096
    buffer_load_dwordx4 v[68:71], v15, s[64:67], s56 offen sc1
    s_add_u32 s56, s56, 4096
    buffer_load_dwordx4 v[72:75], v15, s[64:67], s56 offen sc1
    s_add_u32 s56, s56, 4096
    buffer_load_dwordx4 v[76:79], v15, s[64:67], s56 offen sc1
    s_waitcnt vmcnt(11)
    v_alignbit_b32 v41, v80, v41, 1
    v_alignbit_b32 v41, v81, v41, 1
    v_alignbit_b32 v41, v82, v41, 1
    v_alignbit_b32 v41, v83, v41, 1
    s_waitcnt vmcnt(10)
    v_alignbit_b32 v41, v84, v41, 1
    v_alignbit_b32 v41, v85, v41, 1
    v_alignbit_b32 v41, v86, v41, 1
    v_alignbit_b32 v41, v87, v41, 1
    v_add_f32 v36, v80, v84
    v_add_f32 v37, v81, v85
    v_add_f32 v38, v82, v86
    v_add_f32 v39, v83, v87
    s_waitcnt vmcnt(9)
    v_alignbit_b32 v41, v88, v41, 1
    v_alignbit_b32 v41, v89, v41, 1
    v_alignbit_b32 v41, v90, v41, 1
    v_alignbit_b32 v41, v91, v41, 1
    v_add_f32 v36, v36, v88
    v_add_f32 v37, v37, v89
    v_add_f32 v38, v38, v90
    v_add_f32 v39, v39, v91
    s_waitcnt vmcnt(8)
    v_alignbit_b32 v41, v92, v41, 1
    v_alignbit_b32 v41, v93, v41, 1
    v_alignbit_b32 v41, v94, v41, 1
    v_alignbit_b32 v41, v95, v41, 1
    v_add_f32 v36, v36, v92
    v_add_f32 v37, v37, v93
    v_add_f32 v38, v38, v94
    v_add_f32 v39, v39, v95
    v_xor_b32 v41, v41, v53
    v_cmp_gt_u32 vcc, 0xffff0000, v41
    v_permlane32_swap_b32 v36, v37
    v_permlane32_swap_b32 v38, v39
    v_add_f32 v36, v36, v37
    v_add_f32 v38, v38, v39
    s_cbranch_vccz L_gdone
    s_mov_b32 s56, s79
    buffer_load_dwordx4 v[80:83], v15, s[64:67], s56 offen sc1
    s_add_u32 s56, s56, 4096
    buffer_load_dwordx4 v[84:87], v15, s[64:67], s56 offen sc1
    s_add_u32 s56, s56, 4096
    buffer_load_dwordx4 v[88:91], v15, s[64:67], s56 offen sc1
    s_add_u32 s56, s56, 4096
    buffer_load_dwordx4 v[92:95], v15, s[64:67], s56 offen sc1
    s_waitcnt vmcnt(11)
    v_alignbit_b32 v41, v96, v41, 1
    v_alignbit_b32 v41, v97, v41, 1
    v_alignbit_b32 v41, v98, v41, 1
    v_alignbit_b32 v41, v99, v41, 1
    s_waitcnt vmcnt(10)
    v_alignbit_b32 v41, v100, v41, 1
    v_alignbit_b32 v41, v101, v41, 1
    v_alignbit_b32 v41, v102, v41, 1
    v_alignbit_b32 v41, v103, v41, 1
    v_add_f32 v36, v96, v100
    v_add_f32 v37, v97, v101
    v_add_f32 v38, v98, v102
    v_add_f32 v39, v99, v103
    s_waitcnt vmcnt(9)
    v_alignbit_b32 v41, v104, v41, 1
    v_alignbit_b32 v41, v105, v41, 1
    v_alignbit_b32 v41, v106, v41, 1
    v_alignbit_b32 v41, v107, v41, 1
    v_add_f32 v36, v36, v104
    v_add_f32 v37, v37, v105
    v_add_f32 v38, v38, v106
    v_add_f32 v39, v39, v107
    s_waitcnt vmcnt(8)
    v_alignbit_b32 v41, v108, v41, 1
    v_alignbit_b32 v41, v109, v41, 1
    v_alignbit_b32 v41, v110, v41, 1
    v_alignbit_b32 v41, v111, v41, 1
    v_add_f32 v36, v36, v108
    v_add_f32 v37, v37, v109
    v_add_f32 v38, v38, v110
    v_add_f32 v39, v39, v111
    v_xor_b32 v41, v41, v53
    v_cmp_gt_u32 vcc, 0xffff0000, v41
    v_permlane32_swap_b32 v36, v37
    v_permlane32_swap_b32 v38, v39
    v_add_f32 v36, v36, v37
    v_add_f32 v38, v38, v39
    s_cbranch_vccz L_gdone
    s_mov_b32 s56, s79
    buffer_load_dwordx4 v[96:99], v15, s[64:67], s56 offen sc1
    s_add_u32 s56, s56, 4096
    buffer_load_dwordx4 v[100:103], v15, s[64:67], s56 offen sc1
    s_add_u32 s56, s56, 4096
    buffer_load_dwordx4 v[104:107], v15, s[64:67], s56 offen sc1
    s_add_u32 s56, s56, 4096
    buffer_load_dwordx4 v[108:111], v15, s[64:67], s56 offen sc1
    s_add_u32 s57, s57, 1
    s_cmp_lt_u32 s57, 0x200000
    s_cbranch_scc1 L_gpoll
L_gdone:
    s_nop 0
    v_permlane16_swap_b32 v36, v38
    v_add_f32 v36, v36, v38
    s_nop 1
    v_add_f32_dpp v36, v36, v36 row_ror:8 row_mask:0xf bank_mask:0xf
    v_cvt_pk_bf16_f32 v36, v36, v36
    v_and_b32 v36, 0xffff0000, v36
    v_mul_f32 v36, v36, v56
    v_cvt_pk_bf16_f32 v36, v36, v36
    v_and_b32 v36, 0xffff0000, v36
    v_add_f32 v36, v36, v50
    v_cvt_pk_bf16_f32 v36, v36, v36
    s_mov_b32 exec_lo, 0x00ff00ff
    s_mov_b32 exec_hi, 0x00ff00ff
    buffer_store_short v36, v14, s[72:75], s82 offen
L_hend:
L_end:
    s_endpgm
.section .rodata,"a"
.p2align 6
.amdhsa_kernel recurrent_scan__mha_block_cached__mixer_token_mlp__decode_kernel
  .amdhsa_next_free_vgpr 256
  .amdhsa_next_free_sgpr 96
  .amdhsa_accum_offset 256
  .amdhsa_group_segment_fixed_size 0
  .amdhsa_kernarg_size 104
  .amdhsa_user_sgpr_count 2
  .amdhsa_user_sgpr_kernarg_segment_ptr 1
  .amdhsa_system_sgpr_workgroup_id_x 1
  .amdhsa_float_denorm_mode_32 3
.end_amdhsa_kernel
```
